```python
import torch

def _softmax(x, axis=-1):
    return torch.softmax(x, dim=axis)
def _gelu(x):
    return torch.nn.functional.gelu(x, approximate="tanh")
def _silu(x):
    return torch.nn.functional.silu(x)
def _sigmoid(x):
    return torch.sigmoid(x)
def _layernorm(x, axis=-1, eps=1e-5):
    m = x.mean(dim=axis, keepdim=True)
    v = x.var(dim=axis, keepdim=True, unbiased=False)
    return (x - m) / torch.sqrt(v + eps)
def _scatter_add(tgt, idx, src, axis=0):
    return tgt.clone().index_add_(axis, idx, src)
def _segment_sum(src, seg, n):
    out = torch.zeros((n,) + src.shape[1:], dtype=src.dtype)
    return out.index_add_(0, seg, src)
def _pad(x, pw):
    flat = tuple(v for pair in reversed(pw) for v in pair)
    return torch.nn.functional.pad(x, flat)

kernel_name = 'parallel_sum__linear_kernel_hedgehog__dense_activation_squared_relu__prompt'

def setup_inputs():

    _w = (lambda a: (lambda t: t.to(torch.bfloat16) if t.is_floating_point() else t)(torch.as_tensor(a)))
    def _A_setup():
        B, S, D, H = 1, 2048, 512, 32
        Dh = D // H
        return {
            "x": _w((lambda *s: torch.randn(*s, dtype=torch.bfloat16) * 0.05)(B, S, D)),
            "wqkv": _w((lambda *s: torch.randn(*s, dtype=torch.bfloat16) * 0.8)(D, 3 * D)),
            "w_phi": _w((lambda *s: torch.randn(*s, dtype=torch.bfloat16) * 0.8)(H, Dh, Dh) * (Dh ** -0.5)),
            "wo": _w((lambda *s: torch.randn(*s, dtype=torch.bfloat16) * 0.2)(D, D)),
        }
    _A_in = _A_setup()

    def _B_setup():
        B, S, D, F = 1, 2048, 512, 1792
        return {
            "x": _w((lambda *s: torch.randn(*s, dtype=torch.bfloat16) * 0.05)(B, S, D)),
            "w1": _w((lambda *s: torch.randn(*s, dtype=torch.bfloat16) * 0.05)(D, F)),
            "b1": _w((lambda *s: torch.randn(*s, dtype=torch.bfloat16) * 0.4)(F)),
            "w2": _w((lambda *s: torch.randn(*s, dtype=torch.bfloat16) * 0.05)(F, D)),
            "b2": _w((lambda *s: torch.randn(*s, dtype=torch.bfloat16) * 3.2)(D)),
        }
    _B_in = _B_setup()

    return {
        "A_x": _A_in["x"],
        "A_wqkv": _A_in["wqkv"],
        "A_w_phi": _A_in["w_phi"],
        "A_wo": _A_in["wo"],
        "B_x": _B_in["x"],
        "B_w1": _B_in["w1"],
        "B_b1": _B_in["b1"],
        "B_w2": _B_in["w2"],
        "B_b2": _B_in["b2"],
    }

def reference(A_x, A_wqkv, A_w_phi, A_wo, B_x, B_w1, B_b1, B_w2, B_b2):
    def _A_ref(x, wqkv, w_phi, wo):
        B, S, D = x.shape
        H = 32; Dh = D // H
        qkv = (lambda x, *d: x.permute(*d))((x @ wqkv).reshape(B, S, 3, H, Dh), 2, 0, 3, 1, 4)
        q, k, v = qkv[0], qkv[1], qkv[2]
        pq = torch.einsum("bhsd,hdf->bhsf", q, w_phi)
        pk = torch.einsum("bhsd,hdf->bhsf", k, w_phi)
        phi_q = torch.concatenate([_softmax(pq, axis=-1), _softmax(-pq, axis=-1)], axis=-1)
        phi_k = torch.concatenate([_softmax(pk, axis=-1), _softmax(-pk, axis=-1)], axis=-1)
        kv = torch.einsum("bhsf,bhsd->bhfd", phi_k, v)
        z  = torch.einsum("bhsf->bhf", phi_k)
        num = torch.einsum("bhqf,bhfd->bhqd", phi_q, kv)
        den = torch.einsum("bhqf,bhf->bhq", phi_q, z)[..., None] + 1e-6
        o = num / den
        return (lambda x, *d: x.permute(*d))(o, 0, 2, 1, 3).reshape(B, S, D) @ wo

    def _B_ref(x, w1, b1, w2, b2):
        h = torch.einsum("bsd,df->bsf", x, w1) + b1
        zero = torch.zeros_like(h)
        r = torch.where(h > zero, h, zero)
        h = r * r
        out = torch.einsum("bsf,fd->bsd", h, w2) + b2
        return out

    x = A_x
    xn = _layernorm(x, axis=-1)
    return x + _A_ref(xn, A_wqkv, A_w_phi, A_wo) + _B_ref(xn, B_w1, B_b1, B_w2, B_b2)
```

```asm
; @launch grid=(256,1,1) block=(256,1,1) lds=163840
.amdgcn_target "amdgcn-amd-amdhsa--gfx950"
.text
.set CODE_BYTES, L_code_end - parallel_sum__linear_kernel_hedgehog__dense_activation_squared_relu__prompt_kernel - 128
.globl parallel_sum__linear_kernel_hedgehog__dense_activation_squared_relu__prompt_kernel
.p2align 8
.type parallel_sum__linear_kernel_hedgehog__dense_activation_squared_relu__prompt_kernel,@function
parallel_sum__linear_kernel_hedgehog__dense_activation_squared_relu__prompt_kernel:

    s_cmp_ge_u32 s2, 256
    s_cbranch_scc1 L_end
    s_load_dwordx2 s[4:5], s[0:1], 0
    s_load_dwordx2 s[14:15], s[0:1], 88
    s_load_dwordx2 s[6:7], s[0:1], 8
    s_load_dwordx2 s[8:9], s[0:1], 16
    s_load_dwordx2 s[10:11], s[0:1], 40
    s_load_dwordx2 s[12:13], s[0:1], 48
    s_load_dwordx2 s[16:17], s[0:1], 56
    s_load_dwordx2 s[18:19], s[0:1], 24
    s_load_dwordx2 s[20:21], s[0:1], 64
    s_load_dwordx2 s[22:23], s[0:1], 72
    v_lshrrev_b32 v29, 6, v0
    v_and_b32 v1, 63, v0
    v_readfirstlane_b32 s58, v29
    s_and_b32 s65, s2, 7
    s_lshr_b32 s66, s2, 3
    s_getpc_b64 s[48:49]
    s_and_b32 s49, s49, 65535
    s_mov_b32 s50, CODE_BYTES
    s_mov_b32 s51, 0x00020000
    s_and_b32 s67, s66, 3
    s_lshl_b32 s67, s67, 13
    v_lshlrev_b32 v30, 7, v1
    s_cmp_lg_u32 s58, 3
    s_cbranch_scc1 L_nopf
    buffer_load_dword v28, v30, s[48:51], s67 offen
L_nopf:
    s_lshr_b32 s67, s65, 1
    s_lshl_b32 s67, s67, 3
    s_lshr_b32 s68, s66, 2
    s_add_u32 s56, s67, s68
    s_and_b32 s67, s65, 1
    s_lshl_b32 s67, s67, 2
    s_and_b32 s57, s66, 3
    s_add_u32 s57, s57, s67
    v_lshrrev_b32 v29, 3, v1
    v_and_b32 v30, 7, v1
    s_lshl_b32 s65, s56, 6
    s_lshl_b32 s66, s58, 4
    s_add_u32 s65, s65, s66
    v_add_u32 v31, s65, v29
    v_lshlrev_b32 v31, 10, v31
    v_lshl_add_u32 v31, v30, 4, v31
    s_waitcnt lgkmcnt(0)
    s_mov_b32 s24, s4
    s_and_b32 s25, s5, 65535
    s_mov_b32 s26, 0x200000
    s_mov_b32 s27, 0x00020000
    s_add_u32 s67, s68, 0
    s_and_b32 s67, s67, 7
    s_lshl_b32 s67, s67, 7
    buffer_load_dwordx4 v[32:35], v31, s[24:27], s67 offen
    s_add_u32 s67, s68, 1
    s_and_b32 s67, s67, 7
    s_lshl_b32 s67, s67, 7
    buffer_load_dwordx4 v[36:39], v31, s[24:27], s67 offen
    s_add_u32 s67, s68, 2
    s_and_b32 s67, s67, 7
    s_lshl_b32 s67, s67, 7
    buffer_load_dwordx4 v[40:43], v31, s[24:27], s67 offen
    s_add_u32 s67, s68, 3
    s_and_b32 s67, s67, 7
    s_lshl_b32 s67, s67, 7
    buffer_load_dwordx4 v[44:47], v31, s[24:27], s67 offen
    s_add_u32 s67, s68, 4
    s_and_b32 s67, s67, 7
    s_lshl_b32 s67, s67, 7
    buffer_load_dwordx4 v[48:51], v31, s[24:27], s67 offen
    s_add_u32 s67, s68, 5
    s_and_b32 s67, s67, 7
    s_lshl_b32 s67, s67, 7
    buffer_load_dwordx4 v[52:55], v31, s[24:27], s67 offen
    s_add_u32 s67, s68, 6
    s_and_b32 s67, s67, 7
    s_lshl_b32 s67, s67, 7
    buffer_load_dwordx4 v[56:59], v31, s[24:27], s67 offen
    s_add_u32 s67, s68, 7
    s_and_b32 s67, s67, 7
    s_lshl_b32 s67, s67, 7
    buffer_load_dwordx4 v[60:63], v31, s[24:27], s67 offen
    s_mov_b32 s44, s14
    s_and_b32 s45, s15, 65535
    s_mov_b32 s46, 0x2000000
    s_mov_b32 s47, 0x00020000
    v_mov_b32 v240, 0
    s_mov_b32 s67, 0x1a00000
    buffer_load_dword v28, v240, s[44:47], s67 offen sc0 sc1
    s_add_u32 s67, s68, 0
    s_and_b32 s67, s67, 7
    s_lshl_b32 s67, s67, 7
    s_add_u32 s67, s67, 8192
    buffer_load_dwordx4 v[64:67], v31, s[24:27], s67 offen
    s_add_u32 s67, s68, 1
    s_and_b32 s67, s67, 7
    s_lshl_b32 s67, s67, 7
    s_add_u32 s67, s67, 8192
    buffer_load_dwordx4 v[68:71], v31, s[24:27], s67 offen
    s_add_u32 s67, s68, 2
    s_and_b32 s67, s67, 7
    s_lshl_b32 s67, s67, 7
    s_add_u32 s67, s67, 8192
    buffer_load_dwordx4 v[72:75], v31, s[24:27], s67 offen
    s_add_u32 s67, s68, 3
    s_and_b32 s67, s67, 7
    s_lshl_b32 s67, s67, 7
    s_add_u32 s67, s67, 8192
    buffer_load_dwordx4 v[76:79], v31, s[24:27], s67 offen
    s_add_u32 s67, s68, 4
    s_and_b32 s67, s67, 7
    s_lshl_b32 s67, s67, 7
    s_add_u32 s67, s67, 8192
    buffer_load_dwordx4 v[80:83], v31, s[24:27], s67 offen
    s_add_u32 s67, s68, 5
    s_and_b32 s67, s67, 7
    s_lshl_b32 s67, s67, 7
    s_add_u32 s67, s67, 8192
    buffer_load_dwordx4 v[84:87], v31, s[24:27], s67 offen
    s_add_u32 s67, s68, 6
    s_and_b32 s67, s67, 7
    s_lshl_b32 s67, s67, 7
    s_add_u32 s67, s67, 8192
    buffer_load_dwordx4 v[88:91], v31, s[24:27], s67 offen
    s_add_u32 s67, s68, 7
    s_and_b32 s67, s67, 7
    s_lshl_b32 s67, s67, 7
    s_add_u32 s67, s67, 8192
    buffer_load_dwordx4 v[92:95], v31, s[24:27], s67 offen
    s_lshl_b32 s59, s68, 1
    s_lshl_b32 s60, s58, 10
    s_lshr_b32 s61, s58, 1
    s_and_b32 s62, s58, 1
    s_mul_i32 s63, s57, 7
    s_and_b32 s67, s57, 1
    s_sub_u32 s63, s63, s67
    s_mov_b32 s28, s6
    s_and_b32 s29, s7, 65535
    s_mov_b32 s30, 0x180000
    s_mov_b32 s31, 0x00020000
    s_add_u32 s70, s59, 0
    s_and_b32 s70, s70, 15
    s_add_u32 s71, s59, 1
    s_and_b32 s71, s71, 15
    s_add_u32 s72, s59, 2
    s_and_b32 s72, s72, 15
    s_add_u32 s73, s59, 3
    s_and_b32 s73, s73, 15
    s_add_u32 s74, s59, 4
    s_and_b32 s74, s74, 15
    s_add_u32 s75, s59, 5
    s_and_b32 s75, s75, 15
    s_add_u32 s76, s59, 6
    s_and_b32 s76, s76, 15
    s_add_u32 s77, s59, 7
    s_and_b32 s77, s77, 15
    s_add_u32 s78, s59, 8
    s_and_b32 s78, s78, 15
    s_add_u32 s79, s59, 9
    s_and_b32 s79, s79, 15
    s_add_u32 s80, s59, 10
    s_and_b32 s80, s80, 15
    s_add_u32 s81, s59, 11
    s_and_b32 s81, s81, 15
    s_add_u32 s82, s59, 12
    s_and_b32 s82, s82, 15
    s_add_u32 s83, s59, 13
    s_and_b32 s83, s83, 15
    s_add_u32 s84, s59, 14
    s_and_b32 s84, s84, 15
    s_add_u32 s85, s59, 15
    s_and_b32 s85, s85, 15
    v_xor_b32 v31, v29, v30
    v_lshlrev_b32 v31, 4, v31
    v_add_u32 v29, s66, v29
    v_lshl_add_u32 v26, v29, 10, v31
    v_lshrrev_b32 v241, 4, v1
    v_and_b32 v242, 15, v1
    s_lshl_b32 s65, s58, 2
    v_add_u32 v243, s65, v241
    v_lshlrev_b32 v29, 1, v241
    v_xor_b32 v29, v29, v242
    v_lshrrev_b32 v30, 3, v29
    v_lshlrev_b32 v30, 10, v30
    v_and_b32 v29, 7, v29
    v_lshl_add_u32 v30, v29, 4, v30
    v_mul_u32_u24 v29, 3072, v243
    v_add_u32 v30, v30, v29
    s_lshl_b32 s65, s57, 7
    s_add_u32 s65, s65, 1024
    v_add_u32 v2, s65, v30
    s_barrier
    s_add_u32 m0, s60, 0x10000
    s_mul_i32 s65, s70, 98304
    buffer_load_dwordx4 v2, s[28:31], s65 offen lds
    s_add_u32 m0, s60, 0x11000
    s_mul_i32 s65, s70, 98304
    s_add_u32 s65, s65, 49152
    buffer_load_dwordx4 v2, s[28:31], s65 offen lds
    s_add_u32 m0, s60, 0x12000
    s_mul_i32 s65, s71, 98304
    buffer_load_dwordx4 v2, s[28:31], s65 offen lds
    s_add_u32 m0, s60, 0x13000
    s_mul_i32 s65, s71, 98304
    s_add_u32 s65, s65, 49152
    buffer_load_dwordx4 v2, s[28:31], s65 offen lds
    s_mov_b32 s36, s8
    s_and_b32 s37, s9, 65535
    s_mov_b32 s38, 0x4000
    s_mov_b32 s39, 0x00020000
    s_mov_b32 s40, s12
    s_and_b32 s41, s13, 65535
    s_mov_b32 s42, 0xe00
    s_mov_b32 s43, 0x00020000
    s_mov_b32 s32, s10
    s_and_b32 s33, s11, 65535
    s_mov_b32 s34, 0x1c0000
    s_mov_b32 s35, 0x00020000
    s_mov_b32 s48, s16
    s_and_b32 s49, s17, 65535
    s_mov_b32 s50, 0x1c0000
    s_mov_b32 s51, 0x00020000
    s_mov_b32 s52, s18
    s_and_b32 s53, s19, 65535
    s_mov_b32 s54, 0x80000
    s_mov_b32 s55, 0x00020000
    v_lshlrev_b32 v29, 2, v241
    v_xor_b32 v29, v29, v242
    v_mul_u32_u24 v30, 3584, v243
    v_lshl_add_u32 v30, v29, 4, v30
    s_lshl_b32 s65, s63, 6
    v_add_u32 v3, s65, v30
    v_lshrrev_b32 v29, 2, v1
    v_and_b32 v29, 4, v29
    v_and_b32 v30, 7, v1
    v_xor_b32 v244, v29, v30
    v_lshrrev_b32 v29, 3, v1
    s_lshl_b32 s65, s58, 3
    v_add_u32 v29, s65, v29
    v_mul_u32_u24 v29, 3072, v29
    v_lshl_add_u32 v29, v244, 4, v29
    s_lshl_b32 s65, s57, 7
    v_add_u32 v4, s65, v29
    s_lshr_b32 s65, s2, 3
    s_lshl_b32 s65, s65, 2
    s_add_u32 s65, s65, s58
    s_lshr_b32 s67, s57, 2
    s_lshl_b32 s66, s65, 2
    v_add_u32 v29, s66, v241
    v_mul_u32_u24 v30, 3584, v29
    v_min_u32 v31, 13, v242
    v_lshl_add_u32 v30, v31, 7, v30
    s_mul_i32 s68, s67, 1792
    v_add_u32 v248, s68, v30
    v_and_b32 v31, 3, v1
    v_lshlrev_b32 v31, 7, v31
    s_lshl_b32 s68, s67, 9
    v_add_u32 v31, s68, v31
    v_lshrrev_b32 v29, 2, v1
    v_and_b32 v30, 3, v29
    v_add_u32 v30, s66, v30
    v_lshl_add_u32 v24, v30, 10, v31
    v_mul_u32_u24 v30, 3072, v30
    v_add_u32 v249, v30, v31
    s_mul_i32 s65, s65, 14
    v_min_u32 v29, 13, v29
    v_add_u32 v29, s65, v29
    v_lshl_add_u32 v25, v29, 10, v31
    v_lshrrev_b32 v245, 2, v242
    v_lshrrev_b32 v29, 1, v241
    v_lshl_add_u32 v246, v29, 3, v245
    v_and_b32 v247, 1, v241
    v_and_b32 v250, 3, v242
    v_lshlrev_b32 v250, 3, v250
    v_lshlrev_b32 v30, 2, v247
    v_or_b32 v30, s58, v30
    v_xor_b32 v30, v30, v245
    v_lshl_add_u32 v30, v30, 5, v250
    v_lshl_add_u32 v5, v246, 8, v30
    v_xor_b32 v30, s58, v245
    v_lshl_or_b32 v30, v30, 1, v247
    v_lshl_add_u32 v30, v30, 5, v250
    v_lshl_add_u32 v6, v246, 8, v30
    v_lshrrev_b32 v30, 1, v245
    v_xor_b32 v30, s61, v30
    v_lshl_or_b32 v30, v30, 1, v247
    v_lshl_add_u32 v30, v30, 5, v250
    v_lshl_add_u32 v7, v246, 7, v30
    v_lshrrev_b32 v29, 5, v1
    v_xor_b32 v29, v29, v242
    v_lshlrev_b32 v29, 4, v29
    v_and_b32 v30, 31, v1
    v_lshl_add_u32 v29, v30, 10, v29
    s_lshl_b32 s65, s62, 15
    v_add_u32 v27, s65, v29
    s_and_b32 s65, s57, 3
    s_mul_i32 s66, s58, 14
    s_cmp_eq_u32 s65, 3
    s_cselect_b32 s67, 0, s65
    s_add_u32 s68, s67, 0
    s_sub_u32 s4, s68, 3
    s_cmp_ge_u32 s68, 3
    s_cselect_b32 s4, s4, s68
    s_add_u32 s4, s4, s66
    s_add_u32 s7, s4, 7
    s_add_u32 s68, s67, 1
    s_sub_u32 s5, s68, 3
    s_cmp_ge_u32 s68, 3
    s_cselect_b32 s5, s5, s68
    s_add_u32 s5, s5, s66
    s_add_u32 s8, s5, 7
    s_add_u32 s68, s67, 2
    s_sub_u32 s6, s68, 3
    s_cmp_ge_u32 s68, 3
    s_cselect_b32 s6, s6, s68
    s_add_u32 s6, s6, s66
    s_add_u32 s9, s6, 7
    s_add_u32 s68, s65, 0
    s_and_b32 s68, s68, 3
    s_add_u32 s68, s68, s66
    s_add_u32 s10, s68, 3
    s_add_u32 s14, s68, 10
    s_add_u32 s68, s65, 1
    s_and_b32 s68, s68, 3
    s_add_u32 s68, s68, s66
    s_add_u32 s11, s68, 3
    s_add_u32 s15, s68, 10
    s_add_u32 s68, s65, 2
    s_and_b32 s68, s68, 3
    s_add_u32 s68, s68, s66
    s_add_u32 s12, s68, 3
    s_add_u32 s16, s68, 10
    s_add_u32 s68, s65, 3
    s_and_b32 s68, s68, 3
    s_add_u32 s68, s68, s66
    s_add_u32 s13, s68, 3
    s_add_u32 s17, s68, 10
    v_lshrrev_b32 v29, 5, v1
    v_lshlrev_b32 v29, 2, v29
    v_and_b32 v30, 31, v1
    v_sub_u32 v29, v30, v29
    v_mov_b32 v31, 0x3f80
    v_mov_b32 v9, 0x3f800000
    v_cmp_eq_u32 vcc, 0, v29
    s_nop 1
    v_cndmask_b32 v16, 0, v31, vcc
    v_cmp_eq_u32 vcc, 1, v29
    s_nop 1
    v_cndmask_b32 v16, v16, v9, vcc
    v_cmp_eq_u32 vcc, 2, v29
    s_nop 1
    v_cndmask_b32 v17, 0, v31, vcc
    v_cmp_eq_u32 vcc, 3, v29
    s_nop 1
    v_cndmask_b32 v17, v17, v9, vcc
    v_cmp_eq_u32 vcc, 8, v29
    s_nop 1
    v_cndmask_b32 v18, 0, v31, vcc
    v_cmp_eq_u32 vcc, 9, v29
    s_nop 1
    v_cndmask_b32 v18, v18, v9, vcc
    v_cmp_eq_u32 vcc, 10, v29
    s_nop 1
    v_cndmask_b32 v19, 0, v31, vcc
    v_cmp_eq_u32 vcc, 11, v29
    s_nop 1
    v_cndmask_b32 v19, v19, v9, vcc
    v_cmp_eq_u32 vcc, 16, v29
    s_nop 1
    v_cndmask_b32 v20, 0, v31, vcc
    v_cmp_eq_u32 vcc, 17, v29
    s_nop 1
    v_cndmask_b32 v20, v20, v9, vcc
    v_cmp_eq_u32 vcc, 18, v29
    s_nop 1
    v_cndmask_b32 v21, 0, v31, vcc
    v_cmp_eq_u32 vcc, 19, v29
    s_nop 1
    v_cndmask_b32 v21, v21, v9, vcc
    v_cmp_eq_u32 vcc, 24, v29
    s_nop 1
    v_cndmask_b32 v22, 0, v31, vcc
    v_cmp_eq_u32 vcc, 25, v29
    s_nop 1
    v_cndmask_b32 v22, v22, v9, vcc
    v_cmp_eq_u32 vcc, 26, v29
    s_nop 1
    v_cndmask_b32 v23, 0, v31, vcc
    v_cmp_eq_u32 vcc, 27, v29
    s_nop 1
    v_cndmask_b32 v23, v23, v9, vcc
    v_and_b32 v29, 27, v30
    v_cmp_eq_u32 vcc, 16, v29
    s_nop 1
    v_cndmask_b32 v11, 0, v9, vcc
    v_cmp_ge_u32 s[88:89], 16, v30
    s_waitcnt vmcnt(12)
    v_readfirstlane_b32 s64, v28
    s_nop 0
    s_add_u32 s64, s64, 1
    v_lshlrev_b32 v96, 16, v32
    v_and_b32 v97, 0xffff0000, v32
    v_lshlrev_b32 v98, 16, v33
    v_and_b32 v99, 0xffff0000, v33
    v_lshlrev_b32 v100, 16, v34
    v_and_b32 v101, 0xffff0000, v34
    v_lshlrev_b32 v102, 16, v35
    v_and_b32 v103, 0xffff0000, v35
    v_lshlrev_b32 v104, 16, v36
    v_and_b32 v105, 0xffff0000, v36
    v_lshlrev_b32 v106, 16, v37
    v_and_b32 v107, 0xffff0000, v37
    v_lshlrev_b32 v108, 16, v38
    v_and_b32 v109, 0xffff0000, v38
    v_lshlrev_b32 v110, 16, v39
    v_and_b32 v111, 0xffff0000, v39
    v_lshlrev_b32 v112, 16, v40
    v_and_b32 v113, 0xffff0000, v40
    v_lshlrev_b32 v114, 16, v41
    v_and_b32 v115, 0xffff0000, v41
    v_lshlrev_b32 v116, 16, v42
    v_and_b32 v117, 0xffff0000, v42
    v_lshlrev_b32 v118, 16, v43
    v_and_b32 v119, 0xffff0000, v43
    v_lshlrev_b32 v120, 16, v44
    v_and_b32 v121, 0xffff0000, v44
    v_lshlrev_b32 v122, 16, v45
    v_and_b32 v123, 0xffff0000, v45
    v_lshlrev_b32 v124, 16, v46
    s_add_u32 m0, s60, 0x14000
    s_mul_i32 s65, s72, 98304
    buffer_load_dwordx4 v2, s[28:31], s65 offen lds
    v_and_b32 v125, 0xffff0000, v46
    v_lshlrev_b32 v126, 16, v47
    v_and_b32 v127, 0xffff0000, v47
    v_lshlrev_b32 v128, 16, v48
    v_and_b32 v129, 0xffff0000, v48
    v_lshlrev_b32 v130, 16, v49
    v_and_b32 v131, 0xffff0000, v49
    v_lshlrev_b32 v132, 16, v50
    v_and_b32 v133, 0xffff0000, v50
    v_lshlrev_b32 v134, 16, v51
    v_and_b32 v135, 0xffff0000, v51
    v_lshlrev_b32 v136, 16, v52
    v_and_b32 v137, 0xffff0000, v52
    v_lshlrev_b32 v138, 16, v53
    v_and_b32 v139, 0xffff0000, v53
    v_lshlrev_b32 v140, 16, v54
    v_and_b32 v141, 0xffff0000, v54
    v_lshlrev_b32 v142, 16, v55
    v_and_b32 v143, 0xffff0000, v55
    v_lshlrev_b32 v144, 16, v56
    v_and_b32 v145, 0xffff0000, v56
    v_lshlrev_b32 v146, 16, v57
    v_and_b32 v147, 0xffff0000, v57
    v_lshlrev_b32 v148, 16, v58
    v_and_b32 v149, 0xffff0000, v58
    v_lshlrev_b32 v150, 16, v59
    v_and_b32 v151, 0xffff0000, v59
    v_lshlrev_b32 v152, 16, v60
    v_and_b32 v153, 0xffff0000, v60
    v_lshlrev_b32 v154, 16, v61
    s_add_u32 m0, s60, 0x15000
    s_mul_i32 s65, s72, 98304
    s_add_u32 s65, s65, 49152
    buffer_load_dwordx4 v2, s[28:31], s65 offen lds
    v_and_b32 v155, 0xffff0000, v61
    v_lshlrev_b32 v156, 16, v62
    v_and_b32 v157, 0xffff0000, v62
    v_lshlrev_b32 v158, 16, v63
    v_and_b32 v159, 0xffff0000, v63
    v_pk_add_f32 v[160:161], v[96:97], v[104:105]
    v_pk_add_f32 v[162:163], v[98:99], v[106:107]
    v_pk_add_f32 v[164:165], v[100:101], v[108:109]
    v_pk_add_f32 v[166:167], v[102:103], v[110:111]
    v_pk_add_f32 v[160:161], v[160:161], v[112:113]
    v_pk_add_f32 v[162:163], v[162:163], v[114:115]
    v_pk_add_f32 v[164:165], v[164:165], v[116:117]
    v_pk_add_f32 v[166:167], v[166:167], v[118:119]
    v_pk_add_f32 v[160:161], v[160:161], v[120:121]
    v_pk_add_f32 v[162:163], v[162:163], v[122:123]
    v_pk_add_f32 v[164:165], v[164:165], v[124:125]
    v_pk_add_f32 v[166:167], v[166:167], v[126:127]
    v_pk_add_f32 v[160:161], v[160:161], v[128:129]
    v_pk_add_f32 v[162:163], v[162:163], v[130:131]
    v_pk_add_f32 v[164:165], v[164:165], v[132:133]
    v_pk_add_f32 v[166:167], v[166:167], v[134:135]
    v_pk_add_f32 v[160:161], v[160:161], v[136:137]
    v_pk_add_f32 v[162:163], v[162:163], v[138:139]
    v_pk_add_f32 v[164:165], v[164:165], v[140:141]
    v_pk_add_f32 v[166:167], v[166:167], v[142:143]
    v_pk_add_f32 v[160:161], v[160:161], v[144:145]
    v_pk_add_f32 v[162:163], v[162:163], v[146:147]
    v_pk_add_f32 v[164:165], v[164:165], v[148:149]
    v_pk_add_f32 v[166:167], v[166:167], v[150:151]
    v_pk_add_f32 v[160:161], v[160:161], v[152:153]
    s_add_u32 m0, s60, 0x16000
    s_mul_i32 s65, s73, 98304
    buffer_load_dwordx4 v2, s[28:31], s65 offen lds
    v_pk_add_f32 v[162:163], v[162:163], v[154:155]
    v_pk_add_f32 v[164:165], v[164:165], v[156:157]
    v_pk_add_f32 v[166:167], v[166:167], v[158:159]
    v_pk_add_f32 v[160:161], v[160:161], v[162:163]
    v_pk_add_f32 v[164:165], v[164:165], v[166:167]
    v_pk_add_f32 v[160:161], v[160:161], v[164:165]
    v_add_f32 v160, v160, v161
    s_nop 1
    v_add_f32_dpp v160, v160, v160 quad_perm:[1,0,3,2] row_mask:0xf bank_mask:0xf
    s_nop 1
    v_add_f32_dpp v160, v160, v160 quad_perm:[2,3,0,1] row_mask:0xf bank_mask:0xf
    s_nop 1
    v_add_f32_dpp v160, v160, v160 row_half_mirror row_mask:0xf bank_mask:0xf
    v_mul_f32 v169, 0x3b000000, v160
    v_cvt_pk_bf16_f32 v168, v169, v169
    v_lshlrev_b32 v168, 16, v168
    v_pk_add_f32 v[96:97], v[96:97], v[168:169] op_sel_hi:[1,0] neg_lo:[0,1] neg_hi:[0,1]
    v_pk_add_f32 v[98:99], v[98:99], v[168:169] op_sel_hi:[1,0] neg_lo:[0,1] neg_hi:[0,1]
    v_pk_add_f32 v[100:101], v[100:101], v[168:169] op_sel_hi:[1,0] neg_lo:[0,1] neg_hi:[0,1]
    v_pk_add_f32 v[102:103], v[102:103], v[168:169] op_sel_hi:[1,0] neg_lo:[0,1] neg_hi:[0,1]
    v_pk_add_f32 v[104:105], v[104:105], v[168:169] op_sel_hi:[1,0] neg_lo:[0,1] neg_hi:[0,1]
    v_pk_add_f32 v[106:107], v[106:107], v[168:169] op_sel_hi:[1,0] neg_lo:[0,1] neg_hi:[0,1]
    v_pk_add_f32 v[108:109], v[108:109], v[168:169] op_sel_hi:[1,0] neg_lo:[0,1] neg_hi:[0,1]
    v_pk_add_f32 v[110:111], v[110:111], v[168:169] op_sel_hi:[1,0] neg_lo:[0,1] neg_hi:[0,1]
    v_pk_add_f32 v[112:113], v[112:113], v[168:169] op_sel_hi:[1,0] neg_lo:[0,1] neg_hi:[0,1]
    v_pk_add_f32 v[114:115], v[114:115], v[168:169] op_sel_hi:[1,0] neg_lo:[0,1] neg_hi:[0,1]
    v_pk_add_f32 v[116:117], v[116:117], v[168:169] op_sel_hi:[1,0] neg_lo:[0,1] neg_hi:[0,1]
    v_pk_add_f32 v[118:119], v[118:119], v[168:169] op_sel_hi:[1,0] neg_lo:[0,1] neg_hi:[0,1]
    v_pk_add_f32 v[120:121], v[120:121], v[168:169] op_sel_hi:[1,0] neg_lo:[0,1] neg_hi:[0,1]
    v_pk_add_f32 v[122:123], v[122:123], v[168:169] op_sel_hi:[1,0] neg_lo:[0,1] neg_hi:[0,1]
    v_pk_add_f32 v[124:125], v[124:125], v[168:169] op_sel_hi:[1,0] neg_lo:[0,1] neg_hi:[0,1]
    v_pk_add_f32 v[126:127], v[126:127], v[168:169] op_sel_hi:[1,0] neg_lo:[0,1] neg_hi:[0,1]
    v_pk_add_f32 v[128:129], v[128:129], v[168:169] op_sel_hi:[1,0] neg_lo:[0,1] neg_hi:[0,1]
    s_add_u32 m0, s60, 0x17000
    s_mul_i32 s65, s73, 98304
    s_add_u32 s65, s65, 49152
    buffer_load_dwordx4 v2, s[28:31], s65 offen lds
    v_pk_add_f32 v[130:131], v[130:131], v[168:169] op_sel_hi:[1,0] neg_lo:[0,1] neg_hi:[0,1]
    v_pk_add_f32 v[132:133], v[132:133], v[168:169] op_sel_hi:[1,0] neg_lo:[0,1] neg_hi:[0,1]
    v_pk_add_f32 v[134:135], v[134:135], v[168:169] op_sel_hi:[1,0] neg_lo:[0,1] neg_hi:[0,1]
    v_pk_add_f32 v[136:137], v[136:137], v[168:169] op_sel_hi:[1,0] neg_lo:[0,1] neg_hi:[0,1]
    v_pk_add_f32 v[138:139], v[138:139], v[168:169] op_sel_hi:[1,0] neg_lo:[0,1] neg_hi:[0,1]
    v_pk_add_f32 v[140:141], v[140:141], v[168:169] op_sel_hi:[1,0] neg_lo:[0,1] neg_hi:[0,1]
    v_pk_add_f32 v[142:143], v[142:143], v[168:169] op_sel_hi:[1,0] neg_lo:[0,1] neg_hi:[0,1]
    v_pk_add_f32 v[144:145], v[144:145], v[168:169] op_sel_hi:[1,0] neg_lo:[0,1] neg_hi:[0,1]
    v_pk_add_f32 v[146:147], v[146:147], v[168:169] op_sel_hi:[1,0] neg_lo:[0,1] neg_hi:[0,1]
    v_pk_add_f32 v[148:149], v[148:149], v[168:169] op_sel_hi:[1,0] neg_lo:[0,1] neg_hi:[0,1]
    v_pk_add_f32 v[150:151], v[150:151], v[168:169] op_sel_hi:[1,0] neg_lo:[0,1] neg_hi:[0,1]
    v_pk_add_f32 v[152:153], v[152:153], v[168:169] op_sel_hi:[1,0] neg_lo:[0,1] neg_hi:[0,1]
    v_pk_add_f32 v[154:155], v[154:155], v[168:169] op_sel_hi:[1,0] neg_lo:[0,1] neg_hi:[0,1]
    v_pk_add_f32 v[156:157], v[156:157], v[168:169] op_sel_hi:[1,0] neg_lo:[0,1] neg_hi:[0,1]
    v_pk_add_f32 v[158:159], v[158:159], v[168:169] op_sel_hi:[1,0] neg_lo:[0,1] neg_hi:[0,1]
    v_pk_mul_f32 v[160:161], v[96:97], v[96:97]
    v_pk_mul_f32 v[162:163], v[98:99], v[98:99]
    v_pk_mul_f32 v[164:165], v[100:101], v[100:101]
    v_pk_mul_f32 v[166:167], v[102:103], v[102:103]
    v_pk_fma_f32 v[160:161], v[104:105], v[104:105], v[160:161]
    v_pk_fma_f32 v[162:163], v[106:107], v[106:107], v[162:163]
    v_pk_fma_f32 v[164:165], v[108:109], v[108:109], v[164:165]
    v_pk_fma_f32 v[166:167], v[110:111], v[110:111], v[166:167]
    v_pk_fma_f32 v[160:161], v[112:113], v[112:113], v[160:161]
    v_pk_fma_f32 v[162:163], v[114:115], v[114:115], v[162:163]
    v_pk_fma_f32 v[164:165], v[116:117], v[116:117], v[164:165]
    v_pk_fma_f32 v[166:167], v[118:119], v[118:119], v[166:167]
    v_pk_fma_f32 v[160:161], v[120:121], v[120:121], v[160:161]
    v_pk_fma_f32 v[162:163], v[122:123], v[122:123], v[162:163]
    v_pk_fma_f32 v[164:165], v[124:125], v[124:125], v[164:165]
    s_add_u32 m0, s60, 0x18000
    s_mul_i32 s65, s74, 98304
    buffer_load_dwordx4 v2, s[28:31], s65 offen lds
    v_pk_fma_f32 v[166:167], v[126:127], v[126:127], v[166:167]
    v_pk_fma_f32 v[160:161], v[128:129], v[128:129], v[160:161]
    v_pk_fma_f32 v[162:163], v[130:131], v[130:131], v[162:163]
    v_pk_fma_f32 v[164:165], v[132:133], v[132:133], v[164:165]
    v_pk_fma_f32 v[166:167], v[134:135], v[134:135], v[166:167]
    v_pk_fma_f32 v[160:161], v[136:137], v[136:137], v[160:161]
    v_pk_fma_f32 v[162:163], v[138:139], v[138:139], v[162:163]
    v_pk_fma_f32 v[164:165], v[140:141], v[140:141], v[164:165]
    v_pk_fma_f32 v[166:167], v[142:143], v[142:143], v[166:167]
    v_pk_fma_f32 v[160:161], v[144:145], v[144:145], v[160:161]
    v_pk_fma_f32 v[162:163], v[146:147], v[146:147], v[162:163]
    v_pk_fma_f32 v[164:165], v[148:149], v[148:149], v[164:165]
    v_pk_fma_f32 v[166:167], v[150:151], v[150:151], v[166:167]
    v_pk_fma_f32 v[160:161], v[152:153], v[152:153], v[160:161]
    v_pk_fma_f32 v[162:163], v[154:155], v[154:155], v[162:163]
    v_pk_fma_f32 v[164:165], v[156:157], v[156:157], v[164:165]
    v_pk_fma_f32 v[166:167], v[158:159], v[158:159], v[166:167]
    v_pk_add_f32 v[160:161], v[160:161], v[162:163]
    v_pk_add_f32 v[164:165], v[164:165], v[166:167]
    v_pk_add_f32 v[160:161], v[160:161], v[164:165]
    v_add_f32 v160, v160, v161
    s_nop 1
    v_add_f32_dpp v160, v160, v160 quad_perm:[1,0,3,2] row_mask:0xf bank_mask:0xf
    s_nop 1
    v_add_f32_dpp v160, v160, v160 quad_perm:[2,3,0,1] row_mask:0xf bank_mask:0xf
    s_nop 1
    v_add_f32_dpp v160, v160, v160 row_half_mirror row_mask:0xf bank_mask:0xf
    v_sub_f32 v169, v169, v168
    v_mul_f32 v160, 0x3b000000, v160
    v_fma_f32 v160, -v169, v169, v160
    v_max_f32 v160, 0, v160
    v_cvt_pk_bf16_f32 v160, v160, v160
    v_lshlrev_b32 v160, 16, v160
    s_add_u32 m0, s60, 0x19000
    s_mul_i32 s65, s74, 98304
    s_add_u32 s65, s65, 49152
    buffer_load_dwordx4 v2, s[28:31], s65 offen lds
    v_add_f32 v160, 0x3727c5ac, v160
    v_cvt_pk_bf16_f32 v160, v160, v160
    v_lshlrev_b32 v160, 16, v160
    v_sqrt_f32 v160, v160
    s_nop 0
    v_cvt_pk_bf16_f32 v160, v160, v160
    v_lshlrev_b32 v160, 16, v160
    v_rcp_f32 v170, v160
    s_nop 0
    v_fma_f32 v161, -v160, v170, 1.0
    v_fma_f32 v170, v161, v170, v170
    v_xor_b32 v30, 128, v26
    v_cvt_pk_bf16_f32 v32, v96, v97
    v_cvt_pk_bf16_f32 v33, v98, v99
    v_cvt_pk_bf16_f32 v34, v100, v101
    v_cvt_pk_bf16_f32 v35, v102, v103
    v_lshlrev_b32 v96, 16, v32
    v_and_b32 v97, 0xffff0000, v32
    v_lshlrev_b32 v98, 16, v33
    v_and_b32 v99, 0xffff0000, v33
    v_lshlrev_b32 v100, 16, v34
    v_and_b32 v101, 0xffff0000, v34
    v_lshlrev_b32 v102, 16, v35
    v_and_b32 v103, 0xffff0000, v35
    v_pk_mul_f32 v[96:97], v[96:97], v[170:171] op_sel_hi:[1,0]
    v_pk_mul_f32 v[98:99], v[98:99], v[170:171] op_sel_hi:[1,0]
    v_pk_mul_f32 v[100:101], v[100:101], v[170:171] op_sel_hi:[1,0]
    v_pk_mul_f32 v[102:103], v[102:103], v[170:171] op_sel_hi:[1,0]
    v_cvt_pk_bf16_f32 v32, v96, v97
    v_cvt_pk_bf16_f32 v33, v98, v99
    v_cvt_pk_bf16_f32 v34, v100, v101
    v_cvt_pk_bf16_f32 v35, v102, v103
    s_add_u32 m0, s60, 0x1a000
    s_mul_i32 s65, s75, 98304
    buffer_load_dwordx4 v2, s[28:31], s65 offen lds
    ds_write_b128 v26, v[32:35]
    v_cvt_pk_bf16_f32 v36, v104, v105
    v_cvt_pk_bf16_f32 v37, v106, v107
    v_cvt_pk_bf16_f32 v38, v108, v109
    v_cvt_pk_bf16_f32 v39, v110, v111
    v_lshlrev_b32 v104, 16, v36
    v_and_b32 v105, 0xffff0000, v36
    v_lshlrev_b32 v106, 16, v37
    v_and_b32 v107, 0xffff0000, v37
    v_lshlrev_b32 v108, 16, v38
    v_and_b32 v109, 0xffff0000, v38
    v_lshlrev_b32 v110, 16, v39
    v_and_b32 v111, 0xffff0000, v39
    v_pk_mul_f32 v[104:105], v[104:105], v[170:171] op_sel_hi:[1,0]
    v_pk_mul_f32 v[106:107], v[106:107], v[170:171] op_sel_hi:[1,0]
    v_pk_mul_f32 v[108:109], v[108:109], v[170:171] op_sel_hi:[1,0]
    v_pk_mul_f32 v[110:111], v[110:111], v[170:171] op_sel_hi:[1,0]
    v_cvt_pk_bf16_f32 v36, v104, v105
    v_cvt_pk_bf16_f32 v37, v106, v107
    v_cvt_pk_bf16_f32 v38, v108, v109
    v_cvt_pk_bf16_f32 v39, v110, v111
    ds_write_b128 v30, v[36:39]
    v_cvt_pk_bf16_f32 v40, v112, v113
    v_cvt_pk_bf16_f32 v41, v114, v115
    v_cvt_pk_bf16_f32 v42, v116, v117
    v_cvt_pk_bf16_f32 v43, v118, v119
    v_lshlrev_b32 v112, 16, v40
    v_and_b32 v113, 0xffff0000, v40
    v_lshlrev_b32 v114, 16, v41
    v_and_b32 v115, 0xffff0000, v41
    s_add_u32 m0, s60, 0x1b000
    s_mul_i32 s65, s75, 98304
    s_add_u32 s65, s65, 49152
    buffer_load_dwordx4 v2, s[28:31], s65 offen lds
    v_lshlrev_b32 v116, 16, v42
    v_and_b32 v117, 0xffff0000, v42
    v_lshlrev_b32 v118, 16, v43
    v_and_b32 v119, 0xffff0000, v43
    v_pk_mul_f32 v[112:113], v[112:113], v[170:171] op_sel_hi:[1,0]
    v_pk_mul_f32 v[114:115], v[114:115], v[170:171] op_sel_hi:[1,0]
    v_pk_mul_f32 v[116:117], v[116:117], v[170:171] op_sel_hi:[1,0]
    v_pk_mul_f32 v[118:119], v[118:119], v[170:171] op_sel_hi:[1,0]
    v_cvt_pk_bf16_f32 v40, v112, v113
    v_cvt_pk_bf16_f32 v41, v114, v115
    v_cvt_pk_bf16_f32 v42, v116, v117
    v_cvt_pk_bf16_f32 v43, v118, v119
    ds_write_b128 v26, v[40:43] offset:256
    v_cvt_pk_bf16_f32 v44, v120, v121
    v_cvt_pk_bf16_f32 v45, v122, v123
    v_cvt_pk_bf16_f32 v46, v124, v125
    v_cvt_pk_bf16_f32 v47, v126, v127
    v_lshlrev_b32 v120, 16, v44
    v_and_b32 v121, 0xffff0000, v44
    v_lshlrev_b32 v122, 16, v45
    v_and_b32 v123, 0xffff0000, v45
    v_lshlrev_b32 v124, 16, v46
    v_and_b32 v125, 0xffff0000, v46
    v_lshlrev_b32 v126, 16, v47
    v_and_b32 v127, 0xffff0000, v47
    v_pk_mul_f32 v[120:121], v[120:121], v[170:171] op_sel_hi:[1,0]
    v_pk_mul_f32 v[122:123], v[122:123], v[170:171] op_sel_hi:[1,0]
    v_pk_mul_f32 v[124:125], v[124:125], v[170:171] op_sel_hi:[1,0]
    v_pk_mul_f32 v[126:127], v[126:127], v[170:171] op_sel_hi:[1,0]
    v_cvt_pk_bf16_f32 v44, v120, v121
    s_add_u32 m0, s60, 0x1c000
    s_mul_i32 s65, s76, 98304
    buffer_load_dwordx4 v2, s[28:31], s65 offen lds
    v_cvt_pk_bf16_f32 v45, v122, v123
    v_cvt_pk_bf16_f32 v46, v124, v125
    v_cvt_pk_bf16_f32 v47, v126, v127
    ds_write_b128 v30, v[44:47] offset:256
    v_cvt_pk_bf16_f32 v48, v128, v129
    v_cvt_pk_bf16_f32 v49, v130, v131
    v_cvt_pk_bf16_f32 v50, v132, v133
    v_cvt_pk_bf16_f32 v51, v134, v135
    v_lshlrev_b32 v128, 16, v48
    v_and_b32 v129, 0xffff0000, v48
    v_lshlrev_b32 v130, 16, v49
    v_and_b32 v131, 0xffff0000, v49
    v_lshlrev_b32 v132, 16, v50
    v_and_b32 v133, 0xffff0000, v50
    v_lshlrev_b32 v134, 16, v51
    v_and_b32 v135, 0xffff0000, v51
    v_pk_mul_f32 v[128:129], v[128:129], v[170:171] op_sel_hi:[1,0]
    v_pk_mul_f32 v[130:131], v[130:131], v[170:171] op_sel_hi:[1,0]
    v_pk_mul_f32 v[132:133], v[132:133], v[170:171] op_sel_hi:[1,0]
    v_pk_mul_f32 v[134:135], v[134:135], v[170:171] op_sel_hi:[1,0]
    v_cvt_pk_bf16_f32 v48, v128, v129
    v_cvt_pk_bf16_f32 v49, v130, v131
    v_cvt_pk_bf16_f32 v50, v132, v133
    v_cvt_pk_bf16_f32 v51, v134, v135
    ds_write_b128 v26, v[48:51] offset:512
    v_cvt_pk_bf16_f32 v52, v136, v137
    v_cvt_pk_bf16_f32 v53, v138, v139
    v_cvt_pk_bf16_f32 v54, v140, v141
    v_cvt_pk_bf16_f32 v55, v142, v143
    v_lshlrev_b32 v136, 16, v52
    s_add_u32 m0, s60, 0x1d000
    s_mul_i32 s65, s76, 98304
    s_add_u32 s65, s65, 49152
    buffer_load_dwordx4 v2, s[28:31], s65 offen lds
    v_and_b32 v137, 0xffff0000, v52
    v_lshlrev_b32 v138, 16, v53
    v_and_b32 v139, 0xffff0000, v53
    v_lshlrev_b32 v140, 16, v54
    v_and_b32 v141, 0xffff0000, v54
    v_lshlrev_b32 v142, 16, v55
    v_and_b32 v143, 0xffff0000, v55
    v_pk_mul_f32 v[136:137], v[136:137], v[170:171] op_sel_hi:[1,0]
    v_pk_mul_f32 v[138:139], v[138:139], v[170:171] op_sel_hi:[1,0]
    v_pk_mul_f32 v[140:141], v[140:141], v[170:171] op_sel_hi:[1,0]
    v_pk_mul_f32 v[142:143], v[142:143], v[170:171] op_sel_hi:[1,0]
    v_cvt_pk_bf16_f32 v52, v136, v137
    v_cvt_pk_bf16_f32 v53, v138, v139
    v_cvt_pk_bf16_f32 v54, v140, v141
    v_cvt_pk_bf16_f32 v55, v142, v143
    ds_write_b128 v30, v[52:55] offset:512
    v_cvt_pk_bf16_f32 v56, v144, v145
    v_cvt_pk_bf16_f32 v57, v146, v147
    v_cvt_pk_bf16_f32 v58, v148, v149
    v_cvt_pk_bf16_f32 v59, v150, v151
    v_lshlrev_b32 v144, 16, v56
    v_and_b32 v145, 0xffff0000, v56
    v_lshlrev_b32 v146, 16, v57
    v_and_b32 v147, 0xffff0000, v57
    v_lshlrev_b32 v148, 16, v58
    v_and_b32 v149, 0xffff0000, v58
    v_lshlrev_b32 v150, 16, v59
    v_and_b32 v151, 0xffff0000, v59
    v_pk_mul_f32 v[144:145], v[144:145], v[170:171] op_sel_hi:[1,0]
    v_pk_mul_f32 v[146:147], v[146:147], v[170:171] op_sel_hi:[1,0]
    s_add_u32 m0, s60, 0x1e000
    s_mul_i32 s65, s77, 98304
    buffer_load_dwordx4 v2, s[28:31], s65 offen lds
    v_pk_mul_f32 v[148:149], v[148:149], v[170:171] op_sel_hi:[1,0]
    v_pk_mul_f32 v[150:151], v[150:151], v[170:171] op_sel_hi:[1,0]
    v_cvt_pk_bf16_f32 v56, v144, v145
    v_cvt_pk_bf16_f32 v57, v146, v147
    v_cvt_pk_bf16_f32 v58, v148, v149
    v_cvt_pk_bf16_f32 v59, v150, v151
    ds_write_b128 v26, v[56:59] offset:768
    v_cvt_pk_bf16_f32 v60, v152, v153
    v_cvt_pk_bf16_f32 v61, v154, v155
    v_cvt_pk_bf16_f32 v62, v156, v157
    v_cvt_pk_bf16_f32 v63, v158, v159
    v_lshlrev_b32 v152, 16, v60
    v_and_b32 v153, 0xffff0000, v60
    v_lshlrev_b32 v154, 16, v61
    v_and_b32 v155, 0xffff0000, v61
    v_lshlrev_b32 v156, 16, v62
    v_and_b32 v157, 0xffff0000, v62
    v_lshlrev_b32 v158, 16, v63
    v_and_b32 v159, 0xffff0000, v63
    v_pk_mul_f32 v[152:153], v[152:153], v[170:171] op_sel_hi:[1,0]
    v_pk_mul_f32 v[154:155], v[154:155], v[170:171] op_sel_hi:[1,0]
    v_pk_mul_f32 v[156:157], v[156:157], v[170:171] op_sel_hi:[1,0]
    v_pk_mul_f32 v[158:159], v[158:159], v[170:171] op_sel_hi:[1,0]
    v_cvt_pk_bf16_f32 v60, v152, v153
    v_cvt_pk_bf16_f32 v61, v154, v155
    v_cvt_pk_bf16_f32 v62, v156, v157
    v_cvt_pk_bf16_f32 v63, v158, v159
    ds_write_b128 v30, v[60:63] offset:768
    s_waitcnt vmcnt(15)
    v_lshlrev_b32 v96, 16, v64
    s_add_u32 m0, s60, 0x1f000
    s_mul_i32 s65, s77, 98304
    s_add_u32 s65, s65, 49152
    buffer_load_dwordx4 v2, s[28:31], s65 offen lds
    v_and_b32 v97, 0xffff0000, v64
    v_lshlrev_b32 v98, 16, v65
    v_and_b32 v99, 0xffff0000, v65
    v_lshlrev_b32 v100, 16, v66
    v_and_b32 v101, 0xffff0000, v66
    v_lshlrev_b32 v102, 16, v67
    v_and_b32 v103, 0xffff0000, v67
    v_lshlrev_b32 v104, 16, v68
    v_and_b32 v105, 0xffff0000, v68
    v_lshlrev_b32 v106, 16, v69
    v_and_b32 v107, 0xffff0000, v69
    v_lshlrev_b32 v108, 16, v70
    v_and_b32 v109, 0xffff0000, v70
    v_lshlrev_b32 v110, 16, v71
    v_and_b32 v111, 0xffff0000, v71
    v_lshlrev_b32 v112, 16, v72
    v_and_b32 v113, 0xffff0000, v72
    v_lshlrev_b32 v114, 16, v73
    v_and_b32 v115, 0xffff0000, v73
    v_lshlrev_b32 v116, 16, v74
    v_and_b32 v117, 0xffff0000, v74
    v_lshlrev_b32 v118, 16, v75
    v_and_b32 v119, 0xffff0000, v75
    v_lshlrev_b32 v120, 16, v76
    v_and_b32 v121, 0xffff0000, v76
    v_lshlrev_b32 v122, 16, v77
    v_and_b32 v123, 0xffff0000, v77
    v_lshlrev_b32 v124, 16, v78
    v_and_b32 v125, 0xffff0000, v78
    v_lshlrev_b32 v126, 16, v79
    s_add_u32 m0, s60, 0x20000
    s_mul_i32 s65, s78, 98304
    buffer_load_dwordx4 v2, s[28:31], s65 offen lds
    v_and_b32 v127, 0xffff0000, v79
    v_lshlrev_b32 v128, 16, v80
    v_and_b32 v129, 0xffff0000, v80
    v_lshlrev_b32 v130, 16, v81
    v_and_b32 v131, 0xffff0000, v81
    v_lshlrev_b32 v132, 16, v82
    v_and_b32 v133, 0xffff0000, v82
    v_lshlrev_b32 v134, 16, v83
    v_and_b32 v135, 0xffff0000, v83
    v_lshlrev_b32 v136, 16, v84
    v_and_b32 v137, 0xffff0000, v84
    v_lshlrev_b32 v138, 16, v85
    v_and_b32 v139, 0xffff0000, v85
    v_lshlrev_b32 v140, 16, v86
    v_and_b32 v141, 0xffff0000, v86
    v_lshlrev_b32 v142, 16, v87
    v_and_b32 v143, 0xffff0000, v87
    v_lshlrev_b32 v144, 16, v88
    v_and_b32 v145, 0xffff0000, v88
    v_lshlrev_b32 v146, 16, v89
    v_and_b32 v147, 0xffff0000, v89
    v_lshlrev_b32 v148, 16, v90
    v_and_b32 v149, 0xffff0000, v90
    v_lshlrev_b32 v150, 16, v91
    v_and_b32 v151, 0xffff0000, v91
    v_lshlrev_b32 v152, 16, v92
    v_and_b32 v153, 0xffff0000, v92
    v_lshlrev_b32 v154, 16, v93
    v_and_b32 v155, 0xffff0000, v93
    v_lshlrev_b32 v156, 16, v94
    s_add_u32 m0, s60, 0x21000
    s_mul_i32 s65, s78, 98304
    s_add_u32 s65, s65, 49152
    buffer_load_dwordx4 v2, s[28:31], s65 offen lds
    v_and_b32 v157, 0xffff0000, v94
    v_lshlrev_b32 v158, 16, v95
    v_and_b32 v159, 0xffff0000, v95
    v_pk_add_f32 v[160:161], v[96:97], v[104:105]
    v_pk_add_f32 v[162:163], v[98:99], v[106:107]
    v_pk_add_f32 v[164:165], v[100:101], v[108:109]
    v_pk_add_f32 v[166:167], v[102:103], v[110:111]
    v_pk_add_f32 v[160:161], v[160:161], v[112:113]
    v_pk_add_f32 v[162:163], v[162:163], v[114:115]
    v_pk_add_f32 v[164:165], v[164:165], v[116:117]
    v_pk_add_f32 v[166:167], v[166:167], v[118:119]
    v_pk_add_f32 v[160:161], v[160:161], v[120:121]
    v_pk_add_f32 v[162:163], v[162:163], v[122:123]
    v_pk_add_f32 v[164:165], v[164:165], v[124:125]
    v_pk_add_f32 v[166:167], v[166:167], v[126:127]
    v_pk_add_f32 v[160:161], v[160:161], v[128:129]
    v_pk_add_f32 v[162:163], v[162:163], v[130:131]
    v_pk_add_f32 v[164:165], v[164:165], v[132:133]
    v_pk_add_f32 v[166:167], v[166:167], v[134:135]
    v_pk_add_f32 v[160:161], v[160:161], v[136:137]
    v_pk_add_f32 v[162:163], v[162:163], v[138:139]
    v_pk_add_f32 v[164:165], v[164:165], v[140:141]
    v_pk_add_f32 v[166:167], v[166:167], v[142:143]
    v_pk_add_f32 v[160:161], v[160:161], v[144:145]
    v_pk_add_f32 v[162:163], v[162:163], v[146:147]
    v_pk_add_f32 v[164:165], v[164:165], v[148:149]
    v_pk_add_f32 v[166:167], v[166:167], v[150:151]
    v_pk_add_f32 v[160:161], v[160:161], v[152:153]
    v_pk_add_f32 v[162:163], v[162:163], v[154:155]
    v_pk_add_f32 v[164:165], v[164:165], v[156:157]
    s_add_u32 m0, s60, 0x22000
    s_mul_i32 s65, s79, 98304
    buffer_load_dwordx4 v2, s[28:31], s65 offen lds
    v_pk_add_f32 v[166:167], v[166:167], v[158:159]
    v_pk_add_f32 v[160:161], v[160:161], v[162:163]
    v_pk_add_f32 v[164:165], v[164:165], v[166:167]
    v_pk_add_f32 v[160:161], v[160:161], v[164:165]
    v_add_f32 v160, v160, v161
    s_nop 1
    v_add_f32_dpp v160, v160, v160 quad_perm:[1,0,3,2] row_mask:0xf bank_mask:0xf
    s_nop 1
    v_add_f32_dpp v160, v160, v160 quad_perm:[2,3,0,1] row_mask:0xf bank_mask:0xf
    s_nop 1
    v_add_f32_dpp v160, v160, v160 row_half_mirror row_mask:0xf bank_mask:0xf
    v_mul_f32 v169, 0x3b000000, v160
    v_cvt_pk_bf16_f32 v168, v169, v169
    v_lshlrev_b32 v168, 16, v168
    v_pk_add_f32 v[96:97], v[96:97], v[168:169] op_sel_hi:[1,0] neg_lo:[0,1] neg_hi:[0,1]
    v_pk_add_f32 v[98:99], v[98:99], v[168:169] op_sel_hi:[1,0] neg_lo:[0,1] neg_hi:[0,1]
    v_pk_add_f32 v[100:101], v[100:101], v[168:169] op_sel_hi:[1,0] neg_lo:[0,1] neg_hi:[0,1]
    v_pk_add_f32 v[102:103], v[102:103], v[168:169] op_sel_hi:[1,0] neg_lo:[0,1] neg_hi:[0,1]
    v_pk_add_f32 v[104:105], v[104:105], v[168:169] op_sel_hi:[1,0] neg_lo:[0,1] neg_hi:[0,1]
    v_pk_add_f32 v[106:107], v[106:107], v[168:169] op_sel_hi:[1,0] neg_lo:[0,1] neg_hi:[0,1]
    v_pk_add_f32 v[108:109], v[108:109], v[168:169] op_sel_hi:[1,0] neg_lo:[0,1] neg_hi:[0,1]
    v_pk_add_f32 v[110:111], v[110:111], v[168:169] op_sel_hi:[1,0] neg_lo:[0,1] neg_hi:[0,1]
    v_pk_add_f32 v[112:113], v[112:113], v[168:169] op_sel_hi:[1,0] neg_lo:[0,1] neg_hi:[0,1]
    v_pk_add_f32 v[114:115], v[114:115], v[168:169] op_sel_hi:[1,0] neg_lo:[0,1] neg_hi:[0,1]
    v_pk_add_f32 v[116:117], v[116:117], v[168:169] op_sel_hi:[1,0] neg_lo:[0,1] neg_hi:[0,1]
    v_pk_add_f32 v[118:119], v[118:119], v[168:169] op_sel_hi:[1,0] neg_lo:[0,1] neg_hi:[0,1]
    v_pk_add_f32 v[120:121], v[120:121], v[168:169] op_sel_hi:[1,0] neg_lo:[0,1] neg_hi:[0,1]
    v_pk_add_f32 v[122:123], v[122:123], v[168:169] op_sel_hi:[1,0] neg_lo:[0,1] neg_hi:[0,1]
    v_pk_add_f32 v[124:125], v[124:125], v[168:169] op_sel_hi:[1,0] neg_lo:[0,1] neg_hi:[0,1]
    v_pk_add_f32 v[126:127], v[126:127], v[168:169] op_sel_hi:[1,0] neg_lo:[0,1] neg_hi:[0,1]
    v_pk_add_f32 v[128:129], v[128:129], v[168:169] op_sel_hi:[1,0] neg_lo:[0,1] neg_hi:[0,1]
    v_pk_add_f32 v[130:131], v[130:131], v[168:169] op_sel_hi:[1,0] neg_lo:[0,1] neg_hi:[0,1]
    v_pk_add_f32 v[132:133], v[132:133], v[168:169] op_sel_hi:[1,0] neg_lo:[0,1] neg_hi:[0,1]
    s_add_u32 m0, s60, 0x23000
    s_mul_i32 s65, s79, 98304
    s_add_u32 s65, s65, 49152
    buffer_load_dwordx4 v2, s[28:31], s65 offen lds
    v_pk_add_f32 v[134:135], v[134:135], v[168:169] op_sel_hi:[1,0] neg_lo:[0,1] neg_hi:[0,1]
    v_pk_add_f32 v[136:137], v[136:137], v[168:169] op_sel_hi:[1,0] neg_lo:[0,1] neg_hi:[0,1]
    v_pk_add_f32 v[138:139], v[138:139], v[168:169] op_sel_hi:[1,0] neg_lo:[0,1] neg_hi:[0,1]
    v_pk_add_f32 v[140:141], v[140:141], v[168:169] op_sel_hi:[1,0] neg_lo:[0,1] neg_hi:[0,1]
    v_pk_add_f32 v[142:143], v[142:143], v[168:169] op_sel_hi:[1,0] neg_lo:[0,1] neg_hi:[0,1]
    v_pk_add_f32 v[144:145], v[144:145], v[168:169] op_sel_hi:[1,0] neg_lo:[0,1] neg_hi:[0,1]
    v_pk_add_f32 v[146:147], v[146:147], v[168:169] op_sel_hi:[1,0] neg_lo:[0,1] neg_hi:[0,1]
    v_pk_add_f32 v[148:149], v[148:149], v[168:169] op_sel_hi:[1,0] neg_lo:[0,1] neg_hi:[0,1]
    v_pk_add_f32 v[150:151], v[150:151], v[168:169] op_sel_hi:[1,0] neg_lo:[0,1] neg_hi:[0,1]
    v_pk_add_f32 v[152:153], v[152:153], v[168:169] op_sel_hi:[1,0] neg_lo:[0,1] neg_hi:[0,1]
    v_pk_add_f32 v[154:155], v[154:155], v[168:169] op_sel_hi:[1,0] neg_lo:[0,1] neg_hi:[0,1]
    v_pk_add_f32 v[156:157], v[156:157], v[168:169] op_sel_hi:[1,0] neg_lo:[0,1] neg_hi:[0,1]
    v_pk_add_f32 v[158:159], v[158:159], v[168:169] op_sel_hi:[1,0] neg_lo:[0,1] neg_hi:[0,1]
    v_pk_mul_f32 v[160:161], v[96:97], v[96:97]
    v_pk_mul_f32 v[162:163], v[98:99], v[98:99]
    v_pk_mul_f32 v[164:165], v[100:101], v[100:101]
    v_pk_mul_f32 v[166:167], v[102:103], v[102:103]
    v_pk_fma_f32 v[160:161], v[104:105], v[104:105], v[160:161]
    v_pk_fma_f32 v[162:163], v[106:107], v[106:107], v[162:163]
    v_pk_fma_f32 v[164:165], v[108:109], v[108:109], v[164:165]
    v_pk_fma_f32 v[166:167], v[110:111], v[110:111], v[166:167]
    v_pk_fma_f32 v[160:161], v[112:113], v[112:113], v[160:161]
    v_pk_fma_f32 v[162:163], v[114:115], v[114:115], v[162:163]
    v_pk_fma_f32 v[164:165], v[116:117], v[116:117], v[164:165]
    v_pk_fma_f32 v[166:167], v[118:119], v[118:119], v[166:167]
    v_pk_fma_f32 v[160:161], v[120:121], v[120:121], v[160:161]
    v_pk_fma_f32 v[162:163], v[122:123], v[122:123], v[162:163]
    v_pk_fma_f32 v[164:165], v[124:125], v[124:125], v[164:165]
    v_pk_fma_f32 v[166:167], v[126:127], v[126:127], v[166:167]
    v_pk_fma_f32 v[160:161], v[128:129], v[128:129], v[160:161]
    s_add_u32 m0, s60, 0x24000
    s_mul_i32 s65, s80, 98304
    buffer_load_dwordx4 v2, s[28:31], s65 offen lds
    v_pk_fma_f32 v[162:163], v[130:131], v[130:131], v[162:163]
    v_pk_fma_f32 v[164:165], v[132:133], v[132:133], v[164:165]
    v_pk_fma_f32 v[166:167], v[134:135], v[134:135], v[166:167]
    v_pk_fma_f32 v[160:161], v[136:137], v[136:137], v[160:161]
    v_pk_fma_f32 v[162:163], v[138:139], v[138:139], v[162:163]
    v_pk_fma_f32 v[164:165], v[140:141], v[140:141], v[164:165]
    v_pk_fma_f32 v[166:167], v[142:143], v[142:143], v[166:167]
    v_pk_fma_f32 v[160:161], v[144:145], v[144:145], v[160:161]
    v_pk_fma_f32 v[162:163], v[146:147], v[146:147], v[162:163]
    v_pk_fma_f32 v[164:165], v[148:149], v[148:149], v[164:165]
    v_pk_fma_f32 v[166:167], v[150:151], v[150:151], v[166:167]
    v_pk_fma_f32 v[160:161], v[152:153], v[152:153], v[160:161]
    v_pk_fma_f32 v[162:163], v[154:155], v[154:155], v[162:163]
    v_pk_fma_f32 v[164:165], v[156:157], v[156:157], v[164:165]
    v_pk_fma_f32 v[166:167], v[158:159], v[158:159], v[166:167]
    v_pk_add_f32 v[160:161], v[160:161], v[162:163]
    v_pk_add_f32 v[164:165], v[164:165], v[166:167]
    v_pk_add_f32 v[160:161], v[160:161], v[164:165]
    v_add_f32 v160, v160, v161
    s_nop 1
    v_add_f32_dpp v160, v160, v160 quad_perm:[1,0,3,2] row_mask:0xf bank_mask:0xf
    s_nop 1
    v_add_f32_dpp v160, v160, v160 quad_perm:[2,3,0,1] row_mask:0xf bank_mask:0xf
    s_nop 1
    v_add_f32_dpp v160, v160, v160 row_half_mirror row_mask:0xf bank_mask:0xf
    v_sub_f32 v169, v169, v168
    v_mul_f32 v160, 0x3b000000, v160
    v_fma_f32 v160, -v169, v169, v160
    v_max_f32 v160, 0, v160
    v_cvt_pk_bf16_f32 v160, v160, v160
    v_lshlrev_b32 v160, 16, v160
    v_add_f32 v160, 0x3727c5ac, v160
    v_cvt_pk_bf16_f32 v160, v160, v160
    s_add_u32 m0, s60, 0x25000
    s_mul_i32 s65, s80, 98304
    s_add_u32 s65, s65, 49152
    buffer_load_dwordx4 v2, s[28:31], s65 offen lds
    v_lshlrev_b32 v160, 16, v160
    v_sqrt_f32 v160, v160
    s_nop 0
    v_cvt_pk_bf16_f32 v160, v160, v160
    v_lshlrev_b32 v160, 16, v160
    v_rcp_f32 v170, v160
    s_nop 0
    v_fma_f32 v161, -v160, v170, 1.0
    v_fma_f32 v170, v161, v170, v170
    v_xor_b32 v30, 128, v26
    v_cvt_pk_bf16_f32 v64, v96, v97
    v_cvt_pk_bf16_f32 v65, v98, v99
    v_cvt_pk_bf16_f32 v66, v100, v101
    v_cvt_pk_bf16_f32 v67, v102, v103
    v_lshlrev_b32 v96, 16, v64
    v_and_b32 v97, 0xffff0000, v64
    v_lshlrev_b32 v98, 16, v65
    v_and_b32 v99, 0xffff0000, v65
    v_lshlrev_b32 v100, 16, v66
    v_and_b32 v101, 0xffff0000, v66
    v_lshlrev_b32 v102, 16, v67
    v_and_b32 v103, 0xffff0000, v67
    v_pk_mul_f32 v[96:97], v[96:97], v[170:171] op_sel_hi:[1,0]
    v_pk_mul_f32 v[98:99], v[98:99], v[170:171] op_sel_hi:[1,0]
    v_pk_mul_f32 v[100:101], v[100:101], v[170:171] op_sel_hi:[1,0]
    v_pk_mul_f32 v[102:103], v[102:103], v[170:171] op_sel_hi:[1,0]
    v_cvt_pk_bf16_f32 v64, v96, v97
    v_cvt_pk_bf16_f32 v65, v98, v99
    v_cvt_pk_bf16_f32 v66, v100, v101
    v_cvt_pk_bf16_f32 v67, v102, v103
    ds_write_b128 v30, v[64:67] offset:8192
    v_cvt_pk_bf16_f32 v68, v104, v105
    s_add_u32 m0, s60, 0x26000
    s_mul_i32 s65, s81, 98304
    buffer_load_dwordx4 v2, s[28:31], s65 offen lds
    v_cvt_pk_bf16_f32 v69, v106, v107
    v_cvt_pk_bf16_f32 v70, v108, v109
    v_cvt_pk_bf16_f32 v71, v110, v111
    v_lshlrev_b32 v104, 16, v68
    v_and_b32 v105, 0xffff0000, v68
    v_lshlrev_b32 v106, 16, v69
    v_and_b32 v107, 0xffff0000, v69
    v_lshlrev_b32 v108, 16, v70
    v_and_b32 v109, 0xffff0000, v70
    v_lshlrev_b32 v110, 16, v71
    v_and_b32 v111, 0xffff0000, v71
    v_pk_mul_f32 v[104:105], v[104:105], v[170:171] op_sel_hi:[1,0]
    v_pk_mul_f32 v[106:107], v[106:107], v[170:171] op_sel_hi:[1,0]
    v_pk_mul_f32 v[108:109], v[108:109], v[170:171] op_sel_hi:[1,0]
    v_pk_mul_f32 v[110:111], v[110:111], v[170:171] op_sel_hi:[1,0]
    v_cvt_pk_bf16_f32 v68, v104, v105
    v_cvt_pk_bf16_f32 v69, v106, v107
    v_cvt_pk_bf16_f32 v70, v108, v109
    v_cvt_pk_bf16_f32 v71, v110, v111
    ds_write_b128 v26, v[68:71] offset:8192
    v_cvt_pk_bf16_f32 v72, v112, v113
    v_cvt_pk_bf16_f32 v73, v114, v115
    v_cvt_pk_bf16_f32 v74, v116, v117
    v_cvt_pk_bf16_f32 v75, v118, v119
    v_lshlrev_b32 v112, 16, v72
    v_and_b32 v113, 0xffff0000, v72
    v_lshlrev_b32 v114, 16, v73
    v_and_b32 v115, 0xffff0000, v73
    v_lshlrev_b32 v116, 16, v74
    v_and_b32 v117, 0xffff0000, v74
    s_add_u32 m0, s60, 0x27000
    s_mul_i32 s65, s81, 98304
    s_add_u32 s65, s65, 49152
    buffer_load_dwordx4 v2, s[28:31], s65 offen lds
    v_lshlrev_b32 v118, 16, v75
    v_and_b32 v119, 0xffff0000, v75
    v_pk_mul_f32 v[112:113], v[112:113], v[170:171] op_sel_hi:[1,0]
    v_pk_mul_f32 v[114:115], v[114:115], v[170:171] op_sel_hi:[1,0]
    v_pk_mul_f32 v[116:117], v[116:117], v[170:171] op_sel_hi:[1,0]
    v_pk_mul_f32 v[118:119], v[118:119], v[170:171] op_sel_hi:[1,0]
    v_cvt_pk_bf16_f32 v72, v112, v113
    v_cvt_pk_bf16_f32 v73, v114, v115
    v_cvt_pk_bf16_f32 v74, v116, v117
    v_cvt_pk_bf16_f32 v75, v118, v119
    ds_write_b128 v30, v[72:75] offset:8448
    v_cvt_pk_bf16_f32 v76, v120, v121
    v_cvt_pk_bf16_f32 v77, v122, v123
    v_cvt_pk_bf16_f32 v78, v124, v125
    v_cvt_pk_bf16_f32 v79, v126, v127
    v_lshlrev_b32 v120, 16, v76
    v_and_b32 v121, 0xffff0000, v76
    v_lshlrev_b32 v122, 16, v77
    v_and_b32 v123, 0xffff0000, v77
    v_lshlrev_b32 v124, 16, v78
    v_and_b32 v125, 0xffff0000, v78
    v_lshlrev_b32 v126, 16, v79
    v_and_b32 v127, 0xffff0000, v79
    v_pk_mul_f32 v[120:121], v[120:121], v[170:171] op_sel_hi:[1,0]
    v_pk_mul_f32 v[122:123], v[122:123], v[170:171] op_sel_hi:[1,0]
    v_pk_mul_f32 v[124:125], v[124:125], v[170:171] op_sel_hi:[1,0]
    v_pk_mul_f32 v[126:127], v[126:127], v[170:171] op_sel_hi:[1,0]
    v_cvt_pk_bf16_f32 v76, v120, v121
    v_cvt_pk_bf16_f32 v77, v122, v123
    v_cvt_pk_bf16_f32 v78, v124, v125
    buffer_load_dword v0, v248, s[32:35], 0 offen
    v_cvt_pk_bf16_f32 v79, v126, v127
    ds_write_b128 v26, v[76:79] offset:8448
    v_cvt_pk_bf16_f32 v80, v128, v129
    v_cvt_pk_bf16_f32 v81, v130, v131
    v_cvt_pk_bf16_f32 v82, v132, v133
    v_cvt_pk_bf16_f32 v83, v134, v135
    v_lshlrev_b32 v128, 16, v80
    v_and_b32 v129, 0xffff0000, v80
    v_lshlrev_b32 v130, 16, v81
    v_and_b32 v131, 0xffff0000, v81
    v_lshlrev_b32 v132, 16, v82
    v_and_b32 v133, 0xffff0000, v82
    v_lshlrev_b32 v134, 16, v83
    v_and_b32 v135, 0xffff0000, v83
    v_pk_mul_f32 v[128:129], v[128:129], v[170:171] op_sel_hi:[1,0]
    v_pk_mul_f32 v[130:131], v[130:131], v[170:171] op_sel_hi:[1,0]
    v_pk_mul_f32 v[132:133], v[132:133], v[170:171] op_sel_hi:[1,0]
    v_pk_mul_f32 v[134:135], v[134:135], v[170:171] op_sel_hi:[1,0]
    v_cvt_pk_bf16_f32 v80, v128, v129
    v_cvt_pk_bf16_f32 v81, v130, v131
    v_cvt_pk_bf16_f32 v82, v132, v133
    v_cvt_pk_bf16_f32 v83, v134, v135
    ds_write_b128 v30, v[80:83] offset:8704
    v_cvt_pk_bf16_f32 v84, v136, v137
    v_cvt_pk_bf16_f32 v85, v138, v139
    v_cvt_pk_bf16_f32 v86, v140, v141
    v_cvt_pk_bf16_f32 v87, v142, v143
    v_lshlrev_b32 v136, 16, v84
    v_and_b32 v137, 0xffff0000, v84
    v_lshlrev_b32 v138, 16, v85
    buffer_load_dword v0, v249, s[28:31], 0 offen
    v_and_b32 v139, 0xffff0000, v85
    v_lshlrev_b32 v140, 16, v86
    v_and_b32 v141, 0xffff0000, v86
    v_lshlrev_b32 v142, 16, v87
    v_and_b32 v143, 0xffff0000, v87
    v_pk_mul_f32 v[136:137], v[136:137], v[170:171] op_sel_hi:[1,0]
    v_pk_mul_f32 v[138:139], v[138:139], v[170:171] op_sel_hi:[1,0]
    v_pk_mul_f32 v[140:141], v[140:141], v[170:171] op_sel_hi:[1,0]
    v_pk_mul_f32 v[142:143], v[142:143], v[170:171] op_sel_hi:[1,0]
    v_cvt_pk_bf16_f32 v84, v136, v137
    v_cvt_pk_bf16_f32 v85, v138, v139
    v_cvt_pk_bf16_f32 v86, v140, v141
    v_cvt_pk_bf16_f32 v87, v142, v143
    ds_write_b128 v26, v[84:87] offset:8704
    v_cvt_pk_bf16_f32 v88, v144, v145
    v_cvt_pk_bf16_f32 v89, v146, v147
    v_cvt_pk_bf16_f32 v90, v148, v149
    v_cvt_pk_bf16_f32 v91, v150, v151
    v_lshlrev_b32 v144, 16, v88
    v_and_b32 v145, 0xffff0000, v88
    v_lshlrev_b32 v146, 16, v89
    v_and_b32 v147, 0xffff0000, v89
    v_lshlrev_b32 v148, 16, v90
    v_and_b32 v149, 0xffff0000, v90
    v_lshlrev_b32 v150, 16, v91
    v_and_b32 v151, 0xffff0000, v91
    v_pk_mul_f32 v[144:145], v[144:145], v[170:171] op_sel_hi:[1,0]
    v_pk_mul_f32 v[146:147], v[146:147], v[170:171] op_sel_hi:[1,0]
    v_pk_mul_f32 v[148:149], v[148:149], v[170:171] op_sel_hi:[1,0]
    v_pk_mul_f32 v[150:151], v[150:151], v[170:171] op_sel_hi:[1,0]
    v_cvt_pk_bf16_f32 v88, v144, v145
    v_cvt_pk_bf16_f32 v89, v146, v147
    v_cvt_pk_bf16_f32 v90, v148, v149
    v_cvt_pk_bf16_f32 v91, v150, v151
    ds_write_b128 v30, v[88:91] offset:8960
    v_cvt_pk_bf16_f32 v92, v152, v153
    v_cvt_pk_bf16_f32 v93, v154, v155
    v_cvt_pk_bf16_f32 v94, v156, v157
    v_cvt_pk_bf16_f32 v95, v158, v159
    v_lshlrev_b32 v152, 16, v92
    v_and_b32 v153, 0xffff0000, v92
    v_lshlrev_b32 v154, 16, v93
    v_and_b32 v155, 0xffff0000, v93
    v_lshlrev_b32 v156, 16, v94
    v_and_b32 v157, 0xffff0000, v94
    v_lshlrev_b32 v158, 16, v95
    v_and_b32 v159, 0xffff0000, v95
    v_pk_mul_f32 v[152:153], v[152:153], v[170:171] op_sel_hi:[1,0]
    v_pk_mul_f32 v[154:155], v[154:155], v[170:171] op_sel_hi:[1,0]
    v_pk_mul_f32 v[156:157], v[156:157], v[170:171] op_sel_hi:[1,0]
    v_pk_mul_f32 v[158:159], v[158:159], v[170:171] op_sel_hi:[1,0]
    v_cvt_pk_bf16_f32 v92, v152, v153
    v_cvt_pk_bf16_f32 v93, v154, v155
    v_cvt_pk_bf16_f32 v94, v156, v157
    v_cvt_pk_bf16_f32 v95, v158, v159
    ds_write_b128 v26, v[92:95] offset:8960
    v_xor_b32 v208, 0, v27
    v_xor_b32 v209, 32, v27
    v_xor_b32 v210, 64, v27
    v_xor_b32 v211, 96, v27
    v_xor_b32 v212, 128, v27
    v_xor_b32 v213, 160, v27
    v_xor_b32 v214, 192, v27
    v_xor_b32 v215, 224, v27
    v_xor_b32 v216, 32768, v27
    v_xor_b32 v217, 32800, v27
    v_xor_b32 v218, 32832, v27
    v_xor_b32 v219, 32864, v27
    v_xor_b32 v220, 32896, v27
    v_xor_b32 v221, 32928, v27
    v_xor_b32 v222, 32960, v27
    v_xor_b32 v223, 32992, v27
    s_waitcnt vmcnt(18) lgkmcnt(0)
    s_barrier
    ds_read_b128 a[0:3], v208
    ds_read_b128 a[128:131], v216
    ds_read_b128 a[4:7], v209
    ds_read_b128 a[132:135], v217
    ds_read_b128 a[8:11], v210
    ds_read_b128 a[136:139], v218
    ds_read_b128 a[12:15], v211
    ds_read_b128 a[140:143], v219
    ds_read_b128 a[16:19], v212
    ds_read_b128 a[144:147], v220
    ds_read_b128 a[20:23], v213
    ds_read_b128 a[148:151], v221
    ds_read_b128 a[24:27], v214
    ds_read_b128 a[152:155], v222
    ds_read_b128 a[28:31], v215
    ds_read_b128 a[156:159], v223
    v_add_u32 v8, 0x10000, v5
    ds_read_b64_tr_b16 v[112:113], v8
    ds_read_b64_tr_b16 v[114:115], v8 offset:1024
    ds_read_b64_tr_b16 v[116:117], v8 offset:4096
    ds_read_b64_tr_b16 v[118:119], v8 offset:5120
    ds_read_b64_tr_b16 v[120:121], v8 offset:8192
    ds_read_b64_tr_b16 v[122:123], v8 offset:9216
    ds_read_b64_tr_b16 v[124:125], v8 offset:12288
    ds_read_b64_tr_b16 v[126:127], v8 offset:13312
    s_waitcnt lgkmcnt(0)
    ds_read_b64_tr_b16 v[176:177], v8 offset:16384
    ds_read_b64_tr_b16 v[178:179], v8 offset:17408
    v_mfma_f32_32x32x16_bf16 v[32:47], v[112:115], a[0:3], 0
    ds_read_b64_tr_b16 v[180:181], v8 offset:20480
    ds_read_b64_tr_b16 v[182:183], v8 offset:21504
    ds_read_b64_tr_b16 v[184:185], v8 offset:24576
    ds_read_b64_tr_b16 v[186:187], v8 offset:25600
    ds_read_b64_tr_b16 v[188:189], v8 offset:28672
    ds_read_b64_tr_b16 v[190:191], v8 offset:29696
    ds_read_b128 a[32:35], v208 offset:256
    v_mfma_f32_32x32x16_bf16 v[48:63], v[112:115], a[128:131], 0
    ds_read_b128 a[160:163], v216 offset:256
    ds_read_b128 a[36:39], v209 offset:256
    ds_read_b128 a[164:167], v217 offset:256
    ds_read_b128 a[40:43], v210 offset:256
    ds_read_b128 a[168:171], v218 offset:256
    ds_read_b128 a[44:47], v211 offset:256
    ds_read_b128 a[172:175], v219 offset:256
    v_mfma_f32_32x32x16_bf16 v[32:47], v[116:119], a[4:7], v[32:47]
    ds_read_b128 a[48:51], v212 offset:256
    ds_read_b128 a[176:179], v220 offset:256
    ds_read_b128 a[52:55], v213 offset:256
    ds_read_b128 a[180:183], v221 offset:256
    ds_read_b128 a[56:59], v214 offset:256
    ds_read_b128 a[184:187], v222 offset:256
    ds_read_b128 a[60:63], v215 offset:256
    v_mfma_f32_32x32x16_bf16 v[48:63], v[116:119], a[132:135], v[48:63]
    ds_read_b128 a[188:191], v223 offset:256
    ds_read_b128 a[64:67], v208 offset:512
    ds_read_b128 a[192:195], v216 offset:512
    ds_read_b128 a[68:71], v209 offset:512
    ds_read_b128 a[196:199], v217 offset:512
    ds_read_b128 a[72:75], v210 offset:512
    ds_read_b128 a[200:203], v218 offset:512
    v_mfma_f32_32x32x16_bf16 v[32:47], v[120:123], a[8:11], v[32:47]
    ds_read_b128 a[76:79], v211 offset:512
    ds_read_b128 a[204:207], v219 offset:512
    ds_read_b128 a[80:83], v212 offset:512
    ds_read_b128 a[208:211], v220 offset:512
    ds_read_b128 a[84:87], v213 offset:512
    ds_read_b128 a[212:215], v221 offset:512
    ds_read_b128 a[88:91], v214 offset:512
    v_mfma_f32_32x32x16_bf16 v[48:63], v[120:123], a[136:139], v[48:63]
    ds_read_b128 a[216:219], v222 offset:512
    ds_read_b128 a[92:95], v215 offset:512
    ds_read_b128 a[220:223], v223 offset:512
    ds_read_b128 a[96:99], v208 offset:768
    ds_read_b128 a[224:227], v216 offset:768
    ds_read_b128 a[100:103], v209 offset:768
    ds_read_b128 a[228:231], v217 offset:768
    v_mfma_f32_32x32x16_bf16 v[32:47], v[124:127], a[12:15], v[32:47]
    ds_read_b128 a[104:107], v210 offset:768
    ds_read_b128 a[232:235], v218 offset:768
    ds_read_b128 a[108:111], v211 offset:768
    ds_read_b128 a[236:239], v219 offset:768
    ds_read_b128 a[112:115], v212 offset:768
    ds_read_b128 a[240:243], v220 offset:768
    ds_read_b128 a[116:119], v213 offset:768
    v_mfma_f32_32x32x16_bf16 v[48:63], v[124:127], a[140:143], v[48:63]
    ds_read_b128 a[244:247], v221 offset:768
    ds_read_b128 a[120:123], v214 offset:768
    ds_read_b128 a[248:251], v222 offset:768
    ds_read_b128 a[124:127], v215 offset:768
    ds_read_b128 a[252:255], v223 offset:768
    s_waitcnt vmcnt(10) lgkmcnt(0)
    s_barrier
    ds_read_b64_tr_b16 v[112:113], v8 offset:32768
    ds_read_b64_tr_b16 v[114:115], v8 offset:33792
    v_mfma_f32_32x32x16_bf16 v[32:47], v[176:179], a[16:19], v[32:47]
    ds_read_b64_tr_b16 v[116:117], v8 offset:36864
    ds_read_b64_tr_b16 v[118:119], v8 offset:37888
    v_mfma_f32_32x32x16_bf16 v[48:63], v[176:179], a[144:147], v[48:63]
    s_add_u32 m0, s60, 0x0
    s_mul_i32 s65, s82, 98304
    buffer_load_dwordx4 v2, s[28:31], s65 offen lds
    ds_read_b64_tr_b16 v[120:121], v8 offset:40960
    v_mfma_f32_32x32x16_bf16 v[32:47], v[180:183], a[20:23], v[32:47]
    ds_read_b64_tr_b16 v[122:123], v8 offset:41984
    s_add_u32 m0, s60, 0x1000
    s_mul_i32 s65, s82, 98304
    s_add_u32 s65, s65, 49152
    buffer_load_dwordx4 v2, s[28:31], s65 offen lds
    v_mfma_f32_32x32x16_bf16 v[48:63], v[180:183], a[148:151], v[48:63]
    ds_read_b64_tr_b16 v[124:125], v8 offset:45056
    ds_read_b64_tr_b16 v[126:127], v8 offset:46080
    v_mfma_f32_32x32x16_bf16 v[32:47], v[184:187], a[24:27], v[32:47]
    s_add_u32 m0, s60, 0x2000
    s_mul_i32 s65, s83, 98304
    buffer_load_dwordx4 v2, s[28:31], s65 offen lds
    s_add_u32 m0, s60, 0x3000
    s_mul_i32 s65, s83, 98304
    s_add_u32 s65, s65, 49152
    buffer_load_dwordx4 v2, s[28:31], s65 offen lds
    v_mfma_f32_32x32x16_bf16 v[48:63], v[184:187], a[152:155], v[48:63]
    s_add_u32 m0, s60, 0x4000
    s_mul_i32 s65, s84, 98304
    buffer_load_dwordx4 v2, s[28:31], s65 offen lds
    s_add_u32 m0, s60, 0x5000
    s_mul_i32 s65, s84, 98304
    s_add_u32 s65, s65, 49152
    buffer_load_dwordx4 v2, s[28:31], s65 offen lds
    v_mfma_f32_32x32x16_bf16 v[32:47], v[188:191], a[28:31], v[32:47]
    s_add_u32 m0, s60, 0x6000
    s_mul_i32 s65, s85, 98304
    buffer_load_dwordx4 v2, s[28:31], s65 offen lds
    s_add_u32 m0, s60, 0x7000
    s_mul_i32 s65, s85, 98304
    s_add_u32 s65, s65, 49152
    buffer_load_dwordx4 v2, s[28:31], s65 offen lds
    v_mfma_f32_32x32x16_bf16 v[48:63], v[188:191], a[156:159], v[48:63]
    s_add_u32 m0, s60, 0x8000
    s_mul_i32 s65, s70, 114688
    buffer_load_dwordx4 v3, s[32:35], s65 offen lds
    s_add_u32 m0, s60, 0x9000
    s_mul_i32 s65, s70, 114688
    s_add_u32 s65, s65, 57344
    buffer_load_dwordx4 v3, s[32:35], s65 offen lds
    s_add_u32 m0, s60, 0xa000
    s_mul_i32 s65, s71, 114688
    buffer_load_dwordx4 v3, s[32:35], s65 offen lds
    s_add_u32 m0, s60, 0xb000
    s_mul_i32 s65, s71, 114688
    s_add_u32 s65, s65, 57344
    buffer_load_dwordx4 v3, s[32:35], s65 offen lds
    s_waitcnt lgkmcnt(0)
    ds_read_b64_tr_b16 v[176:177], v8 offset:49152
    ds_read_b64_tr_b16 v[178:179], v8 offset:50176
    v_mfma_f32_32x32x16_bf16 v[32:47], v[112:115], a[32:35], v[32:47]
    ds_read_b64_tr_b16 v[180:181], v8 offset:53248
    ds_read_b64_tr_b16 v[182:183], v8 offset:54272
    v_mfma_f32_32x32x16_bf16 v[48:63], v[112:115], a[160:163], v[48:63]
    s_add_u32 m0, s60, 0xc000
    s_mul_i32 s65, s72, 114688
    buffer_load_dwordx4 v3, s[32:35], s65 offen lds
    ds_read_b64_tr_b16 v[184:185], v8 offset:57344
    v_mfma_f32_32x32x16_bf16 v[32:47], v[116:119], a[36:39], v[32:47]
    ds_read_b64_tr_b16 v[186:187], v8 offset:58368
    s_add_u32 m0, s60, 0xd000
    s_mul_i32 s65, s72, 114688
    s_add_u32 s65, s65, 57344
    buffer_load_dwordx4 v3, s[32:35], s65 offen lds
    v_mfma_f32_32x32x16_bf16 v[48:63], v[116:119], a[164:167], v[48:63]
    ds_read_b64_tr_b16 v[188:189], v8 offset:61440
    ds_read_b64_tr_b16 v[190:191], v8 offset:62464
    v_mfma_f32_32x32x16_bf16 v[32:47], v[120:123], a[40:43], v[32:47]
    s_add_u32 m0, s60, 0xe000
    s_mul_i32 s65, s73, 114688
    buffer_load_dwordx4 v3, s[32:35], s65 offen lds
    s_add_u32 m0, s60, 0xf000
    s_mul_i32 s65, s73, 114688
    s_add_u32 s65, s65, 57344
    buffer_load_dwordx4 v3, s[32:35], s65 offen lds
    v_mfma_f32_32x32x16_bf16 v[48:63], v[120:123], a[168:171], v[48:63]
    s_add_u32 m0, s60, 0x10000
    s_mul_i32 s65, s74, 114688
    buffer_load_dwordx4 v3, s[32:35], s65 offen lds
    s_add_u32 m0, s60, 0x11000
    s_mul_i32 s65, s74, 114688
    s_add_u32 s65, s65, 57344
    buffer_load_dwordx4 v3, s[32:35], s65 offen lds
    v_mfma_f32_32x32x16_bf16 v[32:47], v[124:127], a[44:47], v[32:47]
    s_add_u32 m0, s60, 0x12000
    s_mul_i32 s65, s75, 114688
    buffer_load_dwordx4 v3, s[32:35], s65 offen lds
    s_add_u32 m0, s60, 0x13000
    s_mul_i32 s65, s75, 114688
    s_add_u32 s65, s65, 57344
    buffer_load_dwordx4 v3, s[32:35], s65 offen lds
    v_mfma_f32_32x32x16_bf16 v[48:63], v[124:127], a[172:175], v[48:63]
    s_add_u32 m0, s60, 0x14000
    s_mul_i32 s65, s76, 114688
    buffer_load_dwordx4 v3, s[32:35], s65 offen lds
    s_add_u32 m0, s60, 0x15000
    s_mul_i32 s65, s76, 114688
    s_add_u32 s65, s65, 57344
    buffer_load_dwordx4 v3, s[32:35], s65 offen lds
    s_add_u32 m0, s60, 0x16000
    s_mul_i32 s65, s77, 114688
    buffer_load_dwordx4 v3, s[32:35], s65 offen lds
    s_add_u32 m0, s60, 0x17000
    s_mul_i32 s65, s77, 114688
    s_add_u32 s65, s65, 57344
    buffer_load_dwordx4 v3, s[32:35], s65 offen lds
    s_waitcnt vmcnt(26) lgkmcnt(0)
    s_barrier
    v_lshrrev_b32 v29, 2, v1
    v_and_b32 v30, 4, v29
    v_and_b32 v31, 7, v1
    v_xor_b32 v30, v30, v31
    v_lshlrev_b32 v30, 4, v30
    v_lshrrev_b32 v31, 3, v1
    v_lshl_add_u32 v30, v31, 10, v30
    s_lshl_b32 s65, s57, 7
    v_add_u32 v2, s65, v30
    v_add_u32 v8, 0x20000, v5
    ds_read_b64_tr_b16 v[112:113], v8
    ds_read_b64_tr_b16 v[114:115], v8 offset:1024
    v_mfma_f32_32x32x16_bf16 v[32:47], v[176:179], a[48:51], v[32:47]
    ds_read_b64_tr_b16 v[116:117], v8 offset:4096
    ds_read_b64_tr_b16 v[118:119], v8 offset:5120
    v_mfma_f32_32x32x16_bf16 v[48:63], v[176:179], a[176:179], v[48:63]
    s_add_u32 m0, s60, 0x18000
    s_mul_i32 s65, s78, 114688
    buffer_load_dwordx4 v3, s[32:35], s65 offen lds
    ds_read_b64_tr_b16 v[120:121], v8 offset:8192
    v_mfma_f32_32x32x16_bf16 v[32:47], v[180:183], a[52:55], v[32:47]
    ds_read_b64_tr_b16 v[122:123], v8 offset:9216
    s_add_u32 m0, s60, 0x19000
    s_mul_i32 s65, s78, 114688
    s_add_u32 s65, s65, 57344
    buffer_load_dwordx4 v3, s[32:35], s65 offen lds
    v_mfma_f32_32x32x16_bf16 v[48:63], v[180:183], a[180:183], v[48:63]
    ds_read_b64_tr_b16 v[124:125], v8 offset:12288
    ds_read_b64_tr_b16 v[126:127], v8 offset:13312
    v_mfma_f32_32x32x16_bf16 v[32:47], v[184:187], a[56:59], v[32:47]
    s_add_u32 m0, s60, 0x1a000
    s_mul_i32 s65, s79, 114688
    buffer_load_dwordx4 v3, s[32:35], s65 offen lds
    s_add_u32 m0, s60, 0x1b000
    s_mul_i32 s65, s79, 114688
    s_add_u32 s65, s65, 57344
    buffer_load_dwordx4 v3, s[32:35], s65 offen lds
    v_mfma_f32_32x32x16_bf16 v[48:63], v[184:187], a[184:187], v[48:63]
    s_add_u32 m0, s60, 0x1c000
    s_mul_i32 s65, s80, 114688
    buffer_load_dwordx4 v3, s[32:35], s65 offen lds
    v_mfma_f32_32x32x16_bf16 v[32:47], v[188:191], a[60:63], v[32:47]
    v_mfma_f32_32x32x16_bf16 v[48:63], v[188:191], a[188:191], v[48:63]
    s_waitcnt lgkmcnt(0)
    ds_read_b64_tr_b16 v[176:177], v8 offset:16384
    ds_read_b64_tr_b16 v[178:179], v8 offset:17408
    v_mfma_f32_32x32x16_bf16 v[32:47], v[112:115], a[64:67], v[32:47]
    ds_read_b64_tr_b16 v[180:181], v8 offset:20480
    ds_read_b64_tr_b16 v[182:183], v8 offset:21504
    v_mfma_f32_32x32x16_bf16 v[48:63], v[112:115], a[192:195], v[48:63]
    s_add_u32 m0, s60, 0x1d000
    s_mul_i32 s65, s80, 114688
    s_add_u32 s65, s65, 57344
    buffer_load_dwordx4 v3, s[32:35], s65 offen lds
    ds_read_b64_tr_b16 v[184:185], v8 offset:24576
    v_mfma_f32_32x32x16_bf16 v[32:47], v[116:119], a[68:71], v[32:47]
    ds_read_b64_tr_b16 v[186:187], v8 offset:25600
    s_add_u32 m0, s60, 0x1e000
    s_mul_i32 s65, s81, 114688
    buffer_load_dwordx4 v3, s[32:35], s65 offen lds
    v_mfma_f32_32x32x16_bf16 v[48:63], v[116:119], a[196:199], v[48:63]
    ds_read_b64_tr_b16 v[188:189], v8 offset:28672
    ds_read_b64_tr_b16 v[190:191], v8 offset:29696
    v_mfma_f32_32x32x16_bf16 v[32:47], v[120:123], a[72:75], v[32:47]
    s_add_u32 m0, s60, 0x1f000
    s_mul_i32 s65, s81, 114688
    s_add_u32 s65, s65, 57344
    buffer_load_dwordx4 v3, s[32:35], s65 offen lds
    s_add_u32 s65, s63, s58
    s_lshl_b32 s65, s65, 6
    v_lshrrev_b32 v29, 5, v1
    v_lshlrev_b32 v29, 3, v29
    buffer_load_dwordx2 v[232:233], v29, s[40:43], s65 offen
    buffer_load_dwordx2 v[234:235], v29, s[40:43], s65 offen offset:16
    buffer_load_dwordx2 v[236:237], v29, s[40:43], s65 offen offset:32
    buffer_load_dwordx2 v[238:239], v29, s[40:43], s65 offen offset:48
    v_mfma_f32_32x32x16_bf16 v[48:63], v[120:123], a[200:203], v[48:63]
    v_mfma_f32_32x32x16_bf16 v[32:47], v[124:127], a[76:79], v[32:47]
    v_mfma_f32_32x32x16_bf16 v[48:63], v[124:127], a[204:207], v[48:63]
    s_waitcnt vmcnt(28) lgkmcnt(0)
    s_barrier
    ds_read_b64_tr_b16 v[112:113], v5
    ds_read_b64_tr_b16 v[114:115], v5 offset:1024
    v_mfma_f32_32x32x16_bf16 v[32:47], v[176:179], a[80:83], v[32:47]
    ds_read_b64_tr_b16 v[116:117], v5 offset:4096
    ds_read_b64_tr_b16 v[118:119], v5 offset:5120
    v_mfma_f32_32x32x16_bf16 v[48:63], v[176:179], a[208:211], v[48:63]
    s_lshl_b32 s66, s62, 10
    s_add_u32 m0, s66, 0x20000
    s_lshl_b32 s65, s57, 11
    s_add_u32 s65, s65, s66
    v_lshlrev_b32 v29, 4, v1
    buffer_load_dwordx4 v29, s[36:39], s65 offen lds
    v_and_b32 v30, 15, v1
    v_lshrrev_b32 v31, 2, v30
    v_lshrrev_b32 v29, 5, v1
    v_lshl_add_u32 v31, v29, 2, v31
    v_and_b32 v30, 3, v30
    v_lshlrev_b32 v30, 3, v30
    v_lshl_add_u32 v30, v31, 5, v30
    s_lshl_b32 s65, s58, 9
    s_add_u32 s65, s65, 0x20000
    v_add_u32 v28, s65, v30
    ds_read_b64_tr_b16 v[120:121], v5 offset:8192
    v_mfma_f32_32x32x16_bf16 v[32:47], v[180:183], a[84:87], v[32:47]
    ds_read_b64_tr_b16 v[122:123], v5 offset:9216
    ds_read_b64_tr_b16 v[124:125], v5 offset:12288
    v_mfma_f32_32x32x16_bf16 v[48:63], v[180:183], a[212:215], v[48:63]
    ds_read_b64_tr_b16 v[126:127], v5 offset:13312
    v_mfma_f32_32x32x16_bf16 v[32:47], v[184:187], a[88:91], v[32:47]
    v_mfma_f32_32x32x16_bf16 v[48:63], v[184:187], a[216:219], v[48:63]
    v_mfma_f32_32x32x16_bf16 v[32:47], v[188:191], a[92:95], v[32:47]
    v_mfma_f32_32x32x16_bf16 v[48:63], v[188:191], a[220:223], v[48:63]
    s_waitcnt lgkmcnt(0)
    ds_read_b64_tr_b16 v[176:177], v5 offset:16384
    ds_read_b64_tr_b16 v[178:179], v5 offset:17408
    v_mfma_f32_32x32x16_bf16 v[32:47], v[112:115], a[96:99], v[32:47]
    ds_read_b64_tr_b16 v[180:181], v5 offset:20480
    ds_read_b64_tr_b16 v[182:183], v5 offset:21504
    v_mfma_f32_32x32x16_bf16 v[48:63], v[112:115], a[224:227], v[48:63]
    ds_read_b64_tr_b16 v[184:185], v5 offset:24576
    ds_read_b64_tr_b16 v[186:187], v5 offset:25600
    v_mfma_f32_32x32x16_bf16 v[32:47], v[116:119], a[100:103], v[32:47]
    ds_read_b64_tr_b16 v[188:189], v5 offset:28672
    ds_read_b64_tr_b16 v[190:191], v5 offset:29696
    v_mfma_f32_32x32x16_bf16 v[48:63], v[116:119], a[228:231], v[48:63]
    v_mfma_f32_32x32x16_bf16 v[32:47], v[120:123], a[104:107], v[32:47]
    v_mfma_f32_32x32x16_bf16 v[48:63], v[120:123], a[232:235], v[48:63]
    v_mfma_f32_32x32x16_bf16 v[32:47], v[124:127], a[108:111], v[32:47]
    v_mfma_f32_32x32x16_bf16 v[48:63], v[124:127], a[236:239], v[48:63]
    s_waitcnt vmcnt(0) lgkmcnt(0)
    s_barrier
    ds_read_b64_tr_b16 v[12:13], v28
    ds_read_b64_tr_b16 v[14:15], v28 offset:256
    v_mfma_f32_32x32x16_bf16 v[32:47], v[176:179], a[112:115], v[32:47]
    ds_read_b64_tr_b16 v[112:113], v6 offset:32768
    ds_read_b64_tr_b16 v[114:115], v6 offset:33792
    v_mfma_f32_32x32x16_bf16 v[48:63], v[176:179], a[240:243], v[48:63]
    s_add_u32 m0, s60, 0x0
    s_mul_i32 s65, s82, 114688
    buffer_load_dwordx4 v3, s[32:35], s65 offen lds
    ds_read_b64_tr_b16 v[116:117], v6 offset:36864
    v_mfma_f32_32x32x16_bf16 v[32:47], v[180:183], a[116:119], v[32:47]
    ds_read_b64_tr_b16 v[118:119], v6 offset:37888
    s_add_u32 m0, s60, 0x1000
    s_mul_i32 s65, s82, 114688
    s_add_u32 s65, s65, 57344
    buffer_load_dwordx4 v3, s[32:35], s65 offen lds
    v_mfma_f32_32x32x16_bf16 v[48:63], v[180:183], a[244:247], v[48:63]
    ds_read_b64_tr_b16 v[120:121], v6 offset:40960
    ds_read_b64_tr_b16 v[122:123], v6 offset:41984
    v_mfma_f32_32x32x16_bf16 v[32:47], v[184:187], a[120:123], v[32:47]
    s_add_u32 m0, s60, 0x2000
    s_mul_i32 s65, s83, 114688
    buffer_load_dwordx4 v3, s[32:35], s65 offen lds
    ds_read_b64_tr_b16 v[124:125], v6 offset:45056
    v_mfma_f32_32x32x16_bf16 v[48:63], v[184:187], a[248:251], v[48:63]
    ds_read_b64_tr_b16 v[126:127], v6 offset:46080
    s_add_u32 m0, s60, 0x3000
    s_mul_i32 s65, s83, 114688
    s_add_u32 s65, s65, 57344
    buffer_load_dwordx4 v3, s[32:35], s65 offen lds
    v_mfma_f32_32x32x16_bf16 v[32:47], v[188:191], a[124:127], v[32:47]
    s_add_u32 m0, s60, 0x4000
    s_mul_i32 s65, s84, 114688
    buffer_load_dwordx4 v3, s[32:35], s65 offen lds
    v_mfma_f32_32x32x16_bf16 v[48:63], v[188:191], a[252:255], v[48:63]
    s_waitcnt lgkmcnt(0)
    s_nop 6
    v_cvt_pk_bf16_f32 v240, v32, v33
    v_cvt_pk_bf16_f32 v241, v34, v35
    v_cvt_pk_bf16_f32 v242, v36, v37
    v_cvt_pk_bf16_f32 v243, v38, v39
    v_cvt_pk_bf16_f32 v244, v40, v41
    v_cvt_pk_bf16_f32 v245, v42, v43
    v_cvt_pk_bf16_f32 v246, v44, v45
    v_cvt_pk_bf16_f32 v247, v46, v47
    v_cvt_pk_bf16_f32 v248, v48, v49
    v_cvt_pk_bf16_f32 v249, v50, v51
    v_cvt_pk_bf16_f32 v250, v52, v53
    v_cvt_pk_bf16_f32 v251, v54, v55
    v_cvt_pk_bf16_f32 v252, v56, v57
    v_cvt_pk_bf16_f32 v253, v58, v59
    v_cvt_pk_bf16_f32 v254, v60, v61
    v_cvt_pk_bf16_f32 v255, v62, v63
    s_waitcnt vmcnt(6)
    v_lshlrev_b32 v32, 16, v232
    v_and_b32 v33, 0xffff0000, v232
    v_lshlrev_b32 v34, 16, v233
    v_and_b32 v35, 0xffff0000, v233
    v_lshlrev_b32 v36, 16, v234
    v_and_b32 v37, 0xffff0000, v234
    v_lshlrev_b32 v38, 16, v235
    v_and_b32 v39, 0xffff0000, v235
    v_lshlrev_b32 v40, 16, v236
    v_and_b32 v41, 0xffff0000, v236
    v_lshlrev_b32 v42, 16, v237
    v_and_b32 v43, 0xffff0000, v237
    v_lshlrev_b32 v44, 16, v238
    v_and_b32 v45, 0xffff0000, v238
    v_lshlrev_b32 v46, 16, v239
    v_and_b32 v47, 0xffff0000, v239
    v_lshlrev_b32 v48, 16, v232
    v_and_b32 v49, 0xffff0000, v232
    v_lshlrev_b32 v50, 16, v233
    v_and_b32 v51, 0xffff0000, v233
    v_lshlrev_b32 v52, 16, v234
    v_and_b32 v53, 0xffff0000, v234
    v_lshlrev_b32 v54, 16, v235
    v_and_b32 v55, 0xffff0000, v235
    v_lshlrev_b32 v56, 16, v236
    v_and_b32 v57, 0xffff0000, v236
    v_lshlrev_b32 v58, 16, v237
    v_and_b32 v59, 0xffff0000, v237
    v_lshlrev_b32 v60, 16, v238
    v_and_b32 v61, 0xffff0000, v238
    v_lshlrev_b32 v62, 16, v239
    v_and_b32 v63, 0xffff0000, v239
    ds_read_b64_tr_b16 v[176:177], v6 offset:49152
    ds_read_b64_tr_b16 v[178:179], v6 offset:50176
    v_mfma_f32_32x32x16_bf16 v[32:47], v[112:115], a[0:3], v[32:47]
    ds_read_b64_tr_b16 v[180:181], v6 offset:53248
    ds_read_b64_tr_b16 v[182:183], v6 offset:54272
    v_mov_b32 v10, 0x3fb8aa3b
    v_mov_b32 v160, v11
    v_mov_b32 v161, v11
    v_mov_b32 v162, v11
    v_mov_b32 v163, v11
    v_mov_b32 v164, v11
    v_mov_b32 v165, v11
    v_mov_b32 v166, v11
    v_mov_b32 v167, v11
    v_mov_b32 v168, v11
    v_mov_b32 v169, v11
    v_mov_b32 v170, v11
    v_mfma_f32_32x32x16_bf16 v[48:63], v[112:115], a[128:131], v[48:63]
    s_add_u32 m0, s60, 0x5000
    s_mul_i32 s65, s84, 114688
    s_add_u32 s65, s65, 57344
    buffer_load_dwordx4 v3, s[32:35], s65 offen lds
    ds_read_b64_tr_b16 v[184:185], v6 offset:57344
    v_mov_b32 v171, v11
    v_mov_b32 v172, v11
    v_mov_b32 v173, v11
    v_mov_b32 v174, v11
    v_mov_b32 v175, v11
    s_nop 1
    v_mfma_f32_32x32x16_bf16 v[160:175], v[244:247], v[16:19], v[160:175]
    v_mfma_f32_32x32x16_bf16 v[144:159], v[12:15], v[240:243], 0
    v_mov_b32 v106, 0
    v_mov_b32 v106, 0
    v_mov_b32 v106, 0
    v_mov_b32 v106, 0
    v_mov_b32 v106, 0
    v_mfma_f32_32x32x16_bf16 v[32:47], v[116:119], a[4:7], v[32:47]
    ds_read_b64_tr_b16 v[186:187], v6 offset:58368
    s_add_u32 m0, s60, 0x6000
    s_mul_i32 s65, s85, 114688
    buffer_load_dwordx4 v3, s[32:35], s65 offen lds
    s_nop 0
    v_cvt_pk_bf16_f32 v96, v160, v161
    v_cvt_pk_bf16_f32 v97, v162, v163
    v_cvt_pk_bf16_f32 v98, v164, v165
    v_cvt_pk_bf16_f32 v99, v166, v167
    v_cvt_pk_bf16_f32 v100, v168, v169
    v_cvt_pk_bf16_f32 v101, v170, v171
    v_cvt_pk_bf16_f32 v102, v172, v173
    v_cvt_pk_bf16_f32 v103, v174, v175
    v_cvt_pk_bf16_f32 v160, v144, v145
    v_cvt_pk_bf16_f32 v161, v146, v147
    v_cvt_pk_bf16_f32 v162, v148, v149
    v_cvt_pk_bf16_f32 v163, v150, v151
    v_mfma_f32_32x32x16_bf16 v[48:63], v[116:119], a[132:135], v[48:63]
    ds_read_b64_tr_b16 v[188:189], v6 offset:61440
    ds_read_b64_tr_b16 v[190:191], v6 offset:62464
    v_lshlrev_b32 v144, 16, v160
    v_and_b32 v145, 0xffff0000, v160
    v_lshlrev_b32 v146, 16, v161
    v_and_b32 v147, 0xffff0000, v161
    v_lshlrev_b32 v148, 16, v162
    v_and_b32 v149, 0xffff0000, v162
    v_lshlrev_b32 v150, 16, v163
    v_and_b32 v151, 0xffff0000, v163
    v_max3_f32 v104, v144, v145, v146
    v_max3_f32 v160, v147, v148, v149
    v_max3_f32 v105, -v144, -v145, -v146
    v_max3_f32 v161, -v147, -v148, -v149
    v_mfma_f32_32x32x16_bf16 v[32:47], v[120:123], a[8:11], v[32:47]
    s_add_u32 m0, s60, 0x7000
    s_mul_i32 s65, s85, 114688
    s_add_u32 s65, s65, 57344
    buffer_load_dwordx4 v3, s[32:35], s65 offen lds
    buffer_load_dword v0, v24, s[52:55], 0 offen
    v_max3_f32 v104, v104, v150, v151
    v_max3_f32 v105, v105, -v150, -v151
    v_max_f32 v104, v104, v160
    v_max_f32 v105, v105, v161
    v_mov_b32 v106, 0
    s_nop 0
    v_permlane32_swap_b32 v104, v105
    v_max_f32 v104, v104, v105
    v_mul_f32 v104, 0x3fb8aa3b, v104
    v_mov_b32 v105, v104
    v_mov_b32 v106, 0
    s_nop 0
    v_permlane32_swap_b32 v104, v105
    v_fma_f32 v160, v144, v10, -v104
    v_mfma_f32_32x32x16_bf16 v[48:63], v[120:123], a[136:139], v[48:63]
    buffer_load_dword v0, v25, s[48:51], 0 offen
    v_fma_f32 v161, v145, v10, -v104
    v_fma_f32 v162, v146, v10, -v104
    v_fma_f32 v163, v147, v10, -v104
    v_fma_f32 v164, v148, v10, -v104
    v_fma_f32 v165, v149, v10, -v104
    v_fma_f32 v166, v150, v10, -v104
    v_fma_f32 v167, v151, v10, -v104
    v_fma_f32 v168, -v144, v10, -v105
    v_fma_f32 v169, -v145, v10, -v105
    v_fma_f32 v170, -v146, v10, -v105
    v_fma_f32 v171, -v147, v10, -v105
    v_fma_f32 v172, -v148, v10, -v105
    v_mfma_f32_32x32x16_bf16 v[32:47], v[124:127], a[12:15], v[32:47]
    v_fma_f32 v173, -v149, v10, -v105
    v_fma_f32 v174, -v150, v10, -v105
    v_fma_f32 v175, -v151, v10, -v105
    v_exp_f32 v160, v160
    v_exp_f32 v161, v161
    v_exp_f32 v162, v162
    v_exp_f32 v163, v163
    v_exp_f32 v164, v164
    v_exp_f32 v165, v165
    v_exp_f32 v166, v166
    v_exp_f32 v167, v167
    v_exp_f32 v168, v168
    v_mfma_f32_32x32x16_bf16 v[48:63], v[124:127], a[140:143], v[48:63]
    v_exp_f32 v169, v169
    v_exp_f32 v170, v170
    v_exp_f32 v171, v171
    v_exp_f32 v172, v172
    v_exp_f32 v173, v173
    v_exp_f32 v174, v174
    v_exp_f32 v175, v175
    v_pk_add_f32 v[144:145], v[160:161], v[162:163]
    v_pk_add_f32 v[146:147], v[164:165], v[166:167]
    v_pk_add_f32 v[148:149], v[168:169], v[170:171]
    v_pk_add_f32 v[150:151], v[172:173], v[174:175]
    v_pk_add_f32 v[144:145], v[144:145], v[146:147]
    s_waitcnt vmcnt(23) lgkmcnt(0)
    s_barrier
    v_add_u32 v8, 0x10000, v6
    ds_read_b64_tr_b16 v[112:113], v8
    ds_read_b64_tr_b16 v[114:115], v8 offset:1024
    v_mfma_f32_32x32x16_bf16 v[32:47], v[176:179], a[16:19], v[32:47]
    ds_read_b64_tr_b16 v[116:117], v8 offset:4096
    ds_read_b64_tr_b16 v[118:119], v8 offset:5120
    v_pk_add_f32 v[148:149], v[148:149], v[150:151]
    v_add_f32 v104, v144, v145
    v_add_f32 v105, v148, v149
    v_mov_b32 v106, 0
    s_nop 0
    v_permlane32_swap_b32 v104, v105
    v_add_f32 v104, v104, v105
    v_rcp_f32 v104, v104
    s_nop 0
    v_mov_b32 v105, v104
    v_mov_b32 v106, 0
    s_nop 0
    v_permlane32_swap_b32 v104, v105
    v_mov_b32 v106, v105
    v_pk_mul_f32 v[160:161], v[160:161], v[104:105] op_sel_hi:[1,0]
    v_mfma_f32_32x32x16_bf16 v[48:63], v[176:179], a[144:147], v[48:63]
    s_add_u32 m0, s60, 0x8000
    s_mul_i32 s65, s70, 114688
    s_add_u32 s65, s65, 256
    buffer_load_dwordx4 v3, s[32:35], s65 offen lds
    ds_read_b64_tr_b16 v[120:121], v8 offset:8192
    v_pk_mul_f32 v[162:163], v[162:163], v[104:105] op_sel_hi:[1,0]
    v_pk_mul_f32 v[164:165], v[164:165], v[104:105] op_sel_hi:[1,0]
    v_pk_mul_f32 v[166:167], v[166:167], v[104:105] op_sel_hi:[1,0]
    v_pk_mul_f32 v[168:169], v[168:169], v[106:107] op_sel_hi:[1,0]
    v_pk_mul_f32 v[170:171], v[170:171], v[106:107] op_sel_hi:[1,0]
    v_pk_mul_f32 v[172:173], v[172:173], v[106:107] op_sel_hi:[1,0]
    v_pk_mul_f32 v[174:175], v[174:175], v[106:107] op_sel_hi:[1,0]
    v_cvt_pk_bf16_f32 v224, v160, v161
    v_cvt_pk_bf16_f32 v225, v162, v163
    v_cvt_pk_bf16_f32 v226, v164, v165
    v_cvt_pk_bf16_f32 v227, v166, v167
    v_cvt_pk_bf16_f32 v228, v168, v169
    v_mfma_f32_32x32x16_bf16 v[32:47], v[180:183], a[20:23], v[32:47]
    ds_read_b64_tr_b16 v[122:123], v8 offset:9216
    s_add_u32 m0, s60, 0x9000
    s_mul_i32 s65, s70, 114688
    s_add_u32 s65, s65, 57600
    buffer_load_dwordx4 v3, s[32:35], s65 offen lds
    v_cvt_pk_bf16_f32 v229, v170, v171
    v_cvt_pk_bf16_f32 v230, v172, v173
    v_cvt_pk_bf16_f32 v231, v174, v175
    v_mfma_f32_32x32x16_bf16 v[144:159], v[224:227], v[16:19], 0
    s_nop 0
    v_mfma_f32_32x32x16_bf16 v[144:159], v[228:231], v[20:23], v[144:159]
    v_mov_b32 v106, 0
    v_mov_b32 v106, 0
    v_mov_b32 v106, 0
    v_mov_b32 v106, 0
    v_mov_b32 v106, 0
    v_mov_b32 v106, 0
    s_nop 5
    v_cvt_pk_bf16_f32 v232, v144, v145
    v_mfma_f32_32x32x16_bf16 v[48:63], v[180:183], a[148:151], v[48:63]
    ds_read_b64_tr_b16 v[124:125], v8 offset:12288
    ds_read_b64_tr_b16 v[126:127], v8 offset:13312
    v_cvt_pk_bf16_f32 v233, v146, v147
    v_cvt_pk_bf16_f32 v234, v148, v149
    v_cvt_pk_bf16_f32 v235, v150, v151
    v_cvt_pk_bf16_f32 v236, v152, v153
    v_cvt_pk_bf16_f32 v237, v154, v155
    v_cvt_pk_bf16_f32 v238, v156, v157
    v_cvt_pk_bf16_f32 v239, v158, v159
    v_mfma_f32_32x32x16_bf16 v[208:223], v[232:235], v[96:99], 0
    s_nop 0
    v_mfma_f32_32x32x16_bf16 v[208:223], v[236:239], v[100:103], v[208:223]
    v_mov_b32 v160, v11
    v_mov_b32 v161, v11
    v_mov_b32 v162, v11
    v_mfma_f32_32x32x16_bf16 v[32:47], v[184:187], a[24:27], v[32:47]
    s_add_u32 m0, s60, 0xa000
    s_mul_i32 s65, s71, 114688
    s_add_u32 s65, s65, 256
    buffer_load_dwordx4 v3, s[32:35], s65 offen lds
    s_add_u32 m0, s60, 0xb000
    s_mul_i32 s65, s71, 114688
    s_add_u32 s65, s65, 57600
    buffer_load_dwordx4 v3, s[32:35], s65 offen lds
    v_mov_b32 v163, v11
    v_mov_b32 v164, v11
    v_mov_b32 v165, v11
    v_mov_b32 v166, v11
    v_mov_b32 v167, v11
    v_mov_b32 v168, v11
    v_mov_b32 v169, v11
    v_mov_b32 v170, v11
    v_mov_b32 v171, v11
    v_mov_b32 v172, v11
    v_mov_b32 v173, v11
    v_mov_b32 v174, v11
    v_mfma_f32_32x32x16_bf16 v[48:63], v[184:187], a[152:155], v[48:63]
    v_mov_b32 v175, v11
    s_nop 1
    v_mfma_f32_32x32x16_bf16 v[160:175], v[252:255], v[16:19], v[160:175]
    v_mfma_f32_32x32x16_bf16 v[144:159], v[12:15], v[248:251], 0
    v_mov_b32 v106, 0
    v_mov_b32 v106, 0
    v_mov_b32 v106, 0
    v_mov_b32 v106, 0
    v_mov_b32 v106, 0
    s_nop 5
    v_cvt_pk_bf16_f32 v96, v160, v161
    v_cvt_pk_bf16_f32 v97, v162, v163
    v_cvt_pk_bf16_f32 v98, v164, v165
    v_cvt_pk_bf16_f32 v99, v166, v167
    v_mfma_f32_32x32x16_bf16 v[32:47], v[188:191], a[28:31], v[32:47]
    v_cvt_pk_bf16_f32 v100, v168, v169
    v_cvt_pk_bf16_f32 v101, v170, v171
    v_cvt_pk_bf16_f32 v102, v172, v173
    v_cvt_pk_bf16_f32 v103, v174, v175
    v_cvt_pk_bf16_f32 v160, v144, v145
    v_cvt_pk_bf16_f32 v161, v146, v147
    v_cvt_pk_bf16_f32 v162, v148, v149
    v_cvt_pk_bf16_f32 v163, v150, v151
    v_lshlrev_b32 v144, 16, v160
    v_and_b32 v145, 0xffff0000, v160
    v_lshlrev_b32 v146, 16, v161
    v_and_b32 v147, 0xffff0000, v161
    v_mfma_f32_32x32x16_bf16 v[48:63], v[188:191], a[156:159], v[48:63]
    v_lshlrev_b32 v148, 16, v162
    v_and_b32 v149, 0xffff0000, v162
    v_lshlrev_b32 v150, 16, v163
    v_and_b32 v151, 0xffff0000, v163
    v_max3_f32 v104, v144, v145, v146
    v_max3_f32 v160, v147, v148, v149
    v_max3_f32 v105, -v144, -v145, -v146
    v_max3_f32 v161, -v147, -v148, -v149
    v_max3_f32 v104, v104, v150, v151
    v_max3_f32 v105, v105, -v150, -v151
    v_max_f32 v104, v104, v160
    v_max_f32 v105, v105, v161
    s_waitcnt lgkmcnt(0)
    ds_read_b64_tr_b16 v[176:177], v8 offset:16384
    ds_read_b64_tr_b16 v[178:179], v8 offset:17408
    v_mfma_f32_32x32x16_bf16 v[32:47], v[112:115], a[32:35], v[32:47]
    ds_read_b64_tr_b16 v[180:181], v8 offset:20480
    ds_read_b64_tr_b16 v[182:183], v8 offset:21504
    v_mov_b32 v106, 0
    v_permlane32_swap_b32 v104, v105
    v_max_f32 v104, v104, v105
    v_mul_f32 v104, 0x3fb8aa3b, v104
    v_mov_b32 v105, v104
    v_mov_b32 v106, 0
    s_nop 0
    v_permlane32_swap_b32 v104, v105
    v_fma_f32 v160, v144, v10, -v104
    v_fma_f32 v161, v145, v10, -v104
    v_fma_f32 v162, v146, v10, -v104
    v_fma_f32 v163, v147, v10, -v104
    v_fma_f32 v164, v148, v10, -v104
    v_mfma_f32_32x32x16_bf16 v[48:63], v[112:115], a[160:163], v[48:63]
    s_add_u32 m0, s60, 0xc000
    s_mul_i32 s65, s72, 114688
    s_add_u32 s65, s65, 256
    buffer_load_dwordx4 v3, s[32:35], s65 offen lds
    ds_read_b64_tr_b16 v[184:185], v8 offset:24576
    v_fma_f32 v165, v149, v10, -v104
    v_fma_f32 v166, v150, v10, -v104
    v_fma_f32 v167, v151, v10, -v104
    v_fma_f32 v168, -v144, v10, -v105
    v_fma_f32 v169, -v145, v10, -v105
    v_fma_f32 v170, -v146, v10, -v105
    v_fma_f32 v171, -v147, v10, -v105
    v_fma_f32 v172, -v148, v10, -v105
    v_fma_f32 v173, -v149, v10, -v105
    v_fma_f32 v174, -v150, v10, -v105
    v_fma_f32 v175, -v151, v10, -v105
    v_exp_f32 v160, v160
    v_mfma_f32_32x32x16_bf16 v[32:47], v[116:119], a[36:39], v[32:47]
    ds_read_b64_tr_b16 v[186:187], v8 offset:25600
    s_add_u32 m0, s60, 0xd000
    s_mul_i32 s65, s72, 114688
    s_add_u32 s65, s65, 57600
    buffer_load_dwordx4 v3, s[32:35], s65 offen lds
    v_exp_f32 v161, v161
    v_exp_f32 v162, v162
    v_exp_f32 v163, v163
    v_exp_f32 v164, v164
    v_exp_f32 v165, v165
    v_exp_f32 v166, v166
    v_exp_f32 v167, v167
    v_exp_f32 v168, v168
    v_exp_f32 v169, v169
    v_exp_f32 v170, v170
    v_exp_f32 v171, v171
    v_exp_f32 v172, v172
    v_mfma_f32_32x32x16_bf16 v[48:63], v[116:119], a[164:167], v[48:63]
    ds_read_b64_tr_b16 v[188:189], v8 offset:28672
    ds_read_b64_tr_b16 v[190:191], v8 offset:29696
    v_exp_f32 v173, v173
    v_exp_f32 v174, v174
    v_exp_f32 v175, v175
    v_pk_add_f32 v[144:145], v[160:161], v[162:163]
    v_pk_add_f32 v[146:147], v[164:165], v[166:167]
    v_pk_add_f32 v[148:149], v[168:169], v[170:171]
    v_pk_add_f32 v[150:151], v[172:173], v[174:175]
    v_pk_add_f32 v[144:145], v[144:145], v[146:147]
    v_pk_add_f32 v[148:149], v[148:149], v[150:151]
    v_add_f32 v104, v144, v145
    v_add_f32 v105, v148, v149
    v_mov_b32 v106, 0
    v_mfma_f32_32x32x16_bf16 v[32:47], v[120:123], a[40:43], v[32:47]
    s_add_u32 m0, s60, 0xe000
    s_mul_i32 s65, s73, 114688
    s_add_u32 s65, s65, 256
    buffer_load_dwordx4 v3, s[32:35], s65 offen lds
    s_add_u32 m0, s60, 0xf000
    s_mul_i32 s65, s73, 114688
    s_add_u32 s65, s65, 57600
    buffer_load_dwordx4 v3, s[32:35], s65 offen lds
    v_permlane32_swap_b32 v104, v105
    v_add_f32 v104, v104, v105
    v_rcp_f32 v104, v104
    s_nop 0
    v_mov_b32 v105, v104
    v_mov_b32 v106, 0
    s_nop 0
    v_permlane32_swap_b32 v104, v105
    v_mov_b32 v106, v105
    v_pk_mul_f32 v[160:161], v[160:161], v[104:105] op_sel_hi:[1,0]
    v_pk_mul_f32 v[162:163], v[162:163], v[104:105] op_sel_hi:[1,0]
    v_pk_mul_f32 v[164:165], v[164:165], v[104:105] op_sel_hi:[1,0]
    v_pk_mul_f32 v[166:167], v[166:167], v[104:105] op_sel_hi:[1,0]
    v_pk_mul_f32 v[168:169], v[168:169], v[106:107] op_sel_hi:[1,0]
    v_mfma_f32_32x32x16_bf16 v[48:63], v[120:123], a[168:171], v[48:63]
    v_pk_mul_f32 v[170:171], v[170:171], v[106:107] op_sel_hi:[1,0]
    v_pk_mul_f32 v[172:173], v[172:173], v[106:107] op_sel_hi:[1,0]
    v_pk_mul_f32 v[174:175], v[174:175], v[106:107] op_sel_hi:[1,0]
    v_cvt_pk_bf16_f32 v224, v160, v161
    v_cvt_pk_bf16_f32 v225, v162, v163
    v_cvt_pk_bf16_f32 v226, v164, v165
    v_cvt_pk_bf16_f32 v227, v166, v167
    v_cvt_pk_bf16_f32 v228, v168, v169
    v_cvt_pk_bf16_f32 v229, v170, v171
    v_cvt_pk_bf16_f32 v230, v172, v173
    v_cvt_pk_bf16_f32 v231, v174, v175
    v_mfma_f32_32x32x16_bf16 v[144:159], v[224:227], v[16:19], 0
    v_mfma_f32_32x32x16_bf16 v[32:47], v[124:127], a[44:47], v[32:47]
    v_mfma_f32_32x32x16_bf16 v[144:159], v[228:231], v[20:23], v[144:159]
    v_mov_b32 v106, 0
    v_mov_b32 v106, 0
    v_mov_b32 v106, 0
    v_mov_b32 v106, 0
    v_mov_b32 v106, 0
    v_mov_b32 v106, 0
    s_nop 5
    v_cvt_pk_bf16_f32 v232, v144, v145
    v_cvt_pk_bf16_f32 v233, v146, v147
    v_cvt_pk_bf16_f32 v234, v148, v149
    v_cvt_pk_bf16_f32 v235, v150, v151
    v_cvt_pk_bf16_f32 v236, v152, v153
    v_mfma_f32_32x32x16_bf16 v[48:63], v[124:127], a[172:175], v[48:63]
    v_cvt_pk_bf16_f32 v237, v154, v155
    v_cvt_pk_bf16_f32 v238, v156, v157
    v_cvt_pk_bf16_f32 v239, v158, v159
    v_mfma_f32_32x32x16_bf16 v[208:223], v[232:235], v[96:99], v[208:223]
    s_nop 0
    v_mfma_f32_32x32x16_bf16 v[208:223], v[236:239], v[100:103], v[208:223]
    v_mov_b32 v147, s64
    v_mov_b32 v151, s64
    v_mov_b32 v155, s64
    v_mov_b32 v159, s64
    v_mov_b32 v163, s64
    v_mov_b32 v167, s64
    v_lshlrev_b32 v9, 4, v1
    s_waitcnt vmcnt(23) lgkmcnt(0)
    s_barrier
    ds_read_b64_tr_b16 v[112:113], v8 offset:32768
    ds_read_b64_tr_b16 v[114:115], v8 offset:33792
    v_mfma_f32_32x32x16_bf16 v[32:47], v[176:179], a[48:51], v[32:47]
    ds_read_b64_tr_b16 v[116:117], v8 offset:36864
    ds_read_b64_tr_b16 v[118:119], v8 offset:37888
    v_mov_b32 v144, v208
    v_mov_b32 v145, v209
    v_mov_b32 v146, v210
    v_mov_b32 v148, v211
    v_mov_b32 v149, v212
    v_mov_b32 v150, v213
    v_mov_b32 v152, v214
    v_mov_b32 v153, v215
    v_mov_b32 v154, v216
    v_mov_b32 v156, v217
    v_mov_b32 v157, v218
    v_mov_b32 v158, v219
    v_mfma_f32_32x32x16_bf16 v[48:63], v[176:179], a[176:179], v[48:63]
    s_add_u32 m0, s60, 0x10000
    s_mul_i32 s65, s74, 114688
    s_add_u32 s65, s65, 256
    buffer_load_dwordx4 v3, s[32:35], s65 offen lds
    ds_read_b64_tr_b16 v[120:121], v8 offset:40960
    v_mov_b32 v160, v220
    v_mov_b32 v161, v221
    v_mov_b32 v162, v222
    v_mov_b32 v164, v223
    s_lshl_b32 s0, s57, 2
    s_add_u32 s0, s0, s58
    s_lshl_b32 s0, s0, 5
    s_add_u32 s0, s0, s56
    s_mul_i32 s0, s0, 6144
    s_add_u32 s0, s0, 0x1000000
    s_add_u32 s1, s0, 4096
    s_mov_b64 exec, s[88:89]
    buffer_store_dwordx4 v[144:147], v9, s[44:47], s0 offen sc0 sc1
    buffer_store_dwordx4 v[148:151], v9, s[44:47], s0 offen offset:1024 sc0 sc1
    buffer_store_dwordx4 v[152:155], v9, s[44:47], s0 offen offset:2048 sc0 sc1
    buffer_store_dwordx4 v[156:159], v9, s[44:47], s0 offen offset:3072 sc0 sc1
    buffer_store_dwordx4 v[160:163], v9, s[44:47], s1 offen sc0 sc1
    buffer_store_dwordx4 v[164:167], v9, s[44:47], s1 offen offset:1024 sc0 sc1
    s_mov_b64 exec, -1
    s_lshl_b32 s0, s62, 9
    v_subrev_u32 v9, s0, v28
    ds_read_b64_tr_b16 v[16:17], v9
    ds_read_b64_tr_b16 v[18:19], v9 offset:256
    ds_read_b64_tr_b16 v[20:21], v9 offset:512
    ds_read_b64_tr_b16 v[22:23], v9 offset:768
    v_mfma_f32_32x32x16_bf16 v[32:47], v[180:183], a[52:55], v[32:47]
    ds_read_b64_tr_b16 v[122:123], v8 offset:41984
    s_add_u32 m0, s60, 0x11000
    s_mul_i32 s65, s74, 114688
    s_add_u32 s65, s65, 57600
    buffer_load_dwordx4 v3, s[32:35], s65 offen lds
    v_mfma_f32_32x32x16_bf16 v[48:63], v[180:183], a[180:183], v[48:63]
    ds_read_b64_tr_b16 v[124:125], v8 offset:45056
    ds_read_b64_tr_b16 v[126:127], v8 offset:46080
    v_mfma_f32_32x32x16_bf16 v[32:47], v[184:187], a[56:59], v[32:47]
    s_add_u32 m0, s60, 0x12000
    s_mul_i32 s65, s75, 114688
    s_add_u32 s65, s65, 256
    buffer_load_dwordx4 v3, s[32:35], s65 offen lds
    s_add_u32 m0, s60, 0x13000
    s_mul_i32 s65, s75, 114688
    s_add_u32 s65, s65, 57600
    buffer_load_dwordx4 v3, s[32:35], s65 offen lds
    v_mfma_f32_32x32x16_bf16 v[48:63], v[184:187], a[184:187], v[48:63]
    v_mfma_f32_32x32x16_bf16 v[32:47], v[188:191], a[60:63], v[32:47]
    v_mfma_f32_32x32x16_bf16 v[48:63], v[188:191], a[188:191], v[48:63]
    s_waitcnt lgkmcnt(0)
    ds_read_b64_tr_b16 v[176:177], v8 offset:49152
    ds_read_b64_tr_b16 v[178:179], v8 offset:50176
    v_mfma_f32_32x32x16_bf16 v[32:47], v[112:115], a[64:67], v[32:47]
    ds_read_b64_tr_b16 v[180:181], v8 offset:53248
    ds_read_b64_tr_b16 v[182:183], v8 offset:54272
    v_mfma_f32_32x32x16_bf16 v[48:63], v[112:115], a[192:195], v[48:63]
    s_add_u32 m0, s60, 0x14000
    s_mul_i32 s65, s76, 114688
    s_add_u32 s65, s65, 256
    buffer_load_dwordx4 v3, s[32:35], s65 offen lds
    ds_read_b64_tr_b16 v[184:185], v8 offset:57344
    v_mfma_f32_32x32x16_bf16 v[32:47], v[116:119], a[68:71], v[32:47]
    ds_read_b64_tr_b16 v[186:187], v8 offset:58368
    s_add_u32 m0, s60, 0x15000
    s_mul_i32 s65, s76, 114688
    s_add_u32 s65, s65, 57600
    buffer_load_dwordx4 v3, s[32:35], s65 offen lds
    v_mfma_f32_32x32x16_bf16 v[48:63], v[116:119], a[196:199], v[48:63]
    ds_read_b64_tr_b16 v[188:189], v8 offset:61440
    ds_read_b64_tr_b16 v[190:191], v8 offset:62464
    v_mfma_f32_32x32x16_bf16 v[32:47], v[120:123], a[72:75], v[32:47]
    s_add_u32 m0, s60, 0x16000
    s_mul_i32 s65, s77, 114688
    s_add_u32 s65, s65, 256
    buffer_load_dwordx4 v3, s[32:35], s65 offen lds
    s_add_u32 m0, s60, 0x17000
    s_mul_i32 s65, s77, 114688
    s_add_u32 s65, s65, 57600
    buffer_load_dwordx4 v3, s[32:35], s65 offen lds
    v_mfma_f32_32x32x16_bf16 v[48:63], v[120:123], a[200:203], v[48:63]
    v_mfma_f32_32x32x16_bf16 v[32:47], v[124:127], a[76:79], v[32:47]
    v_mfma_f32_32x32x16_bf16 v[48:63], v[124:127], a[204:207], v[48:63]
    s_waitcnt vmcnt(24) lgkmcnt(0)
    s_barrier
    ds_read_b64_tr_b16 v[112:113], v6
    ds_read_b64_tr_b16 v[114:115], v6 offset:1024
    v_mfma_f32_32x32x16_bf16 v[32:47], v[176:179], a[80:83], v[32:47]
    ds_read_b64_tr_b16 v[116:117], v6 offset:4096
    ds_read_b64_tr_b16 v[118:119], v6 offset:5120
    v_mfma_f32_32x32x16_bf16 v[48:63], v[176:179], a[208:211], v[48:63]
    s_add_u32 s65, s63, s58
    s_lshl_b32 s65, s65, 6
    v_lshrrev_b32 v29, 5, v1
    v_lshlrev_b32 v29, 3, v29
    buffer_load_dwordx2 v[88:89], v29, s[40:43], s65 offen offset:256
    buffer_load_dwordx2 v[90:91], v29, s[40:43], s65 offen offset:272
    buffer_load_dwordx2 v[92:93], v29, s[40:43], s65 offen offset:288
    buffer_load_dwordx2 v[94:95], v29, s[40:43], s65 offen offset:304
    ds_read_b64_tr_b16 v[120:121], v6 offset:8192
    v_mfma_f32_32x32x16_bf16 v[32:47], v[180:183], a[84:87], v[32:47]
    ds_read_b64_tr_b16 v[122:123], v6 offset:9216
    s_add_u32 m0, s60, 0x18000
    s_mul_i32 s65, s78, 114688
    s_add_u32 s65, s65, 256
    buffer_load_dwordx4 v3, s[32:35], s65 offen lds
    v_mfma_f32_32x32x16_bf16 v[48:63], v[180:183], a[212:215], v[48:63]
    ds_read_b64_tr_b16 v[124:125], v6 offset:12288
    ds_read_b64_tr_b16 v[126:127], v6 offset:13312
    v_mfma_f32_32x32x16_bf16 v[32:47], v[184:187], a[88:91], v[32:47]
    s_add_u32 m0, s60, 0x19000
    s_mul_i32 s65, s78, 114688
    s_add_u32 s65, s65, 57600
    buffer_load_dwordx4 v3, s[32:35], s65 offen lds
    s_add_u32 m0, s60, 0x1a000
    s_mul_i32 s65, s79, 114688
    s_add_u32 s65, s65, 256
    buffer_load_dwordx4 v3, s[32:35], s65 offen lds
    v_mfma_f32_32x32x16_bf16 v[48:63], v[184:187], a[216:219], v[48:63]
    s_add_u32 m0, s60, 0x1b000
    s_mul_i32 s65, s79, 114688
    s_add_u32 s65, s65, 57600
    buffer_load_dwordx4 v3, s[32:35], s65 offen lds
    v_mfma_f32_32x32x16_bf16 v[32:47], v[188:191], a[92:95], v[32:47]
    v_mfma_f32_32x32x16_bf16 v[48:63], v[188:191], a[220:223], v[48:63]
    s_waitcnt lgkmcnt(0)
    ds_read_b64_tr_b16 v[176:177], v6 offset:16384
    ds_read_b64_tr_b16 v[178:179], v6 offset:17408
    v_mfma_f32_32x32x16_bf16 v[32:47], v[112:115], a[96:99], v[32:47]
    ds_read_b64_tr_b16 v[180:181], v6 offset:20480
    ds_read_b64_tr_b16 v[182:183], v6 offset:21504
    v_mfma_f32_32x32x16_bf16 v[48:63], v[112:115], a[224:227], v[48:63]
    s_add_u32 m0, s60, 0x1c000
    s_mul_i32 s65, s80, 114688
    s_add_u32 s65, s65, 256
    buffer_load_dwordx4 v3, s[32:35], s65 offen lds
    ds_read_b64_tr_b16 v[184:185], v6 offset:24576
    v_mfma_f32_32x32x16_bf16 v[32:47], v[116:119], a[100:103], v[32:47]
    ds_read_b64_tr_b16 v[186:187], v6 offset:25600
    s_add_u32 m0, s60, 0x1d000
    s_mul_i32 s65, s80, 114688
    s_add_u32 s65, s65, 57600
    buffer_load_dwordx4 v3, s[32:35], s65 offen lds
    v_mfma_f32_32x32x16_bf16 v[48:63], v[116:119], a[228:231], v[48:63]
    ds_read_b64_tr_b16 v[188:189], v6 offset:28672
    ds_read_b64_tr_b16 v[190:191], v6 offset:29696
    v_mfma_f32_32x32x16_bf16 v[32:47], v[120:123], a[104:107], v[32:47]
    s_add_u32 m0, s60, 0x1e000
    s_mul_i32 s65, s81, 114688
    s_add_u32 s65, s65, 256
    buffer_load_dwordx4 v3, s[32:35], s65 offen lds
    s_add_u32 m0, s60, 0x1f000
    s_mul_i32 s65, s81, 114688
    s_add_u32 s65, s65, 57600
    buffer_load_dwordx4 v3, s[32:35], s65 offen lds
    v_mfma_f32_32x32x16_bf16 v[48:63], v[120:123], a[232:235], v[48:63]
    v_mfma_f32_32x32x16_bf16 v[32:47], v[124:127], a[108:111], v[32:47]
    v_mfma_f32_32x32x16_bf16 v[48:63], v[124:127], a[236:239], v[48:63]
    s_waitcnt vmcnt(26) lgkmcnt(0)
    s_barrier
    ds_read_b64_tr_b16 v[112:113], v6 offset:32768
    ds_read_b64_tr_b16 v[114:115], v6 offset:33792
    v_mfma_f32_32x32x16_bf16 v[32:47], v[176:179], a[112:115], v[32:47]
    ds_read_b64_tr_b16 v[116:117], v6 offset:36864
    ds_read_b64_tr_b16 v[118:119], v6 offset:37888
    s_mov_b32 s69, -1
    s_lshr_b32 s0, s56, 3
    s_and_b32 s1, s56, 7
    v_and_b32 v10, 3, v1
    s_cmp_eq_u32 s0, s58
    s_cbranch_scc1 L_red_kv
    s_add_u32 s3, s58, 1
    s_and_b32 s3, s3, 3
    s_cmp_lg_u32 s0, s3
    s_cbranch_scc1 L_nored1
    s_cmp_ge_u32 s1, 2
    s_cbranch_scc1 L_nored1
    s_lshl_b32 s3, s1, 9
    s_add_u32 s3, s3, 256
    v_mov_b32 v10, 0
    s_branch L_red_go
L_red_kv:
    s_lshr_b32 s3, s1, 2
    s_lshl_b32 s3, s3, 9
    s_and_b32 s1, s1, 3
    s_lshl_b32 s1, s1, 6
    s_add_u32 s3, s3, s1
L_red_go:
    s_lshl_b32 s0, s57, 2
    s_add_u32 s0, s0, s58
    s_mul_i32 s0, s0, 196608
    s_add_u32 s0, s0, s3
    s_add_u32 s69, s0, 0x1000000
    v_lshrrev_b32 v9, 2, v1
    v_mul_u32_u24 v9, 6144, v9
    v_lshl_add_u32 v24, v10, 4, v9
    v_add_u32 v25, 0x18000, v24
    v_add_u32 v26, 4096, v24
    v_add_u32 v27, 4096, v25
    v_lshlrev_b32 v11, 4, v10
    buffer_load_dwordx4 v[144:147], v24, s[44:47], s69 offen sc0 sc1
    buffer_load_dwordx4 v[148:151], v24, s[44:47], s69 offen offset:1024 sc0 sc1
    buffer_load_dwordx4 v[152:155], v24, s[44:47], s69 offen offset:2048 sc0 sc1
    buffer_load_dwordx4 v[156:159], v24, s[44:47], s69 offen offset:3072 sc0 sc1
    buffer_load_dwordx4 v[160:163], v26, s[44:47], s69 offen sc0 sc1
    buffer_load_dwordx4 v[164:167], v26, s[44:47], s69 offen offset:1024 sc0 sc1
    buffer_load_dwordx4 v[168:171], v25, s[44:47], s69 offen sc0 sc1
    buffer_load_dwordx4 v[172:175], v25, s[44:47], s69 offen offset:1024 sc0 sc1
    buffer_load_dwordx4 v[208:211], v25, s[44:47], s69 offen offset:2048 sc0 sc1
    buffer_load_dwordx4 v[212:215], v25, s[44:47], s69 offen offset:3072 sc0 sc1
    buffer_load_dwordx4 v[216:219], v27, s[44:47], s69 offen sc0 sc1
    buffer_load_dwordx4 v[220:223], v27, s[44:47], s69 offen offset:1024 sc0 sc1
L_nored1:
    v_mfma_f32_32x32x16_bf16 v[48:63], v[176:179], a[240:243], v[48:63]
    s_add_u32 m0, s60, 0x0
    s_mul_i32 s65, s82, 114688
    s_add_u32 s65, s65, 256
    buffer_load_dwordx4 v3, s[32:35], s65 offen lds
    ds_read_b64_tr_b16 v[120:121], v6 offset:40960
    v_mfma_f32_32x32x16_bf16 v[32:47], v[180:183], a[116:119], v[32:47]
    ds_read_b64_tr_b16 v[122:123], v6 offset:41984
    s_add_u32 m0, s60, 0x1000
    s_mul_i32 s65, s82, 114688
    s_add_u32 s65, s65, 57600
    buffer_load_dwordx4 v3, s[32:35], s65 offen lds
    v_mfma_f32_32x32x16_bf16 v[48:63], v[180:183], a[244:247], v[48:63]
    ds_read_b64_tr_b16 v[124:125], v6 offset:45056
    ds_read_b64_tr_b16 v[126:127], v6 offset:46080
    v_mfma_f32_32x32x16_bf16 v[32:47], v[184:187], a[120:123], v[32:47]
    s_add_u32 m0, s60, 0x2000
    s_mul_i32 s65, s83, 114688
    s_add_u32 s65, s65, 256
    buffer_load_dwordx4 v3, s[32:35], s65 offen lds
    s_add_u32 m0, s60, 0x3000
    s_mul_i32 s65, s83, 114688
    s_add_u32 s65, s65, 57600
    buffer_load_dwordx4 v3, s[32:35], s65 offen lds
    v_mfma_f32_32x32x16_bf16 v[48:63], v[184:187], a[248:251], v[48:63]
    v_mfma_f32_32x32x16_bf16 v[32:47], v[188:191], a[124:127], v[32:47]
    v_mfma_f32_32x32x16_bf16 v[48:63], v[188:191], a[252:255], v[48:63]
    s_waitcnt lgkmcnt(0)
    s_waitcnt vmcnt(12)
    v_lshlrev_b32 v64, 16, v88
    v_and_b32 v65, 0xffff0000, v88
    v_lshlrev_b32 v66, 16, v89
    v_and_b32 v67, 0xffff0000, v89
    v_lshlrev_b32 v68, 16, v90
    v_and_b32 v69, 0xffff0000, v90
    v_lshlrev_b32 v70, 16, v91
    v_and_b32 v71, 0xffff0000, v91
    v_lshlrev_b32 v72, 16, v92
    v_and_b32 v73, 0xffff0000, v92
    v_lshlrev_b32 v74, 16, v93
    v_and_b32 v75, 0xffff0000, v93
    v_lshlrev_b32 v76, 16, v94
    v_and_b32 v77, 0xffff0000, v94
    v_lshlrev_b32 v78, 16, v95
    v_and_b32 v79, 0xffff0000, v95
    v_lshlrev_b32 v80, 16, v88
    v_and_b32 v81, 0xffff0000, v88
    v_lshlrev_b32 v82, 16, v89
    v_and_b32 v83, 0xffff0000, v89
    v_lshlrev_b32 v84, 16, v90
    v_and_b32 v85, 0xffff0000, v90
    v_lshlrev_b32 v86, 16, v91
    v_and_b32 v87, 0xffff0000, v91
    v_lshlrev_b32 v88, 16, v92
    v_and_b32 v89, 0xffff0000, v92
    v_lshlrev_b32 v90, 16, v93
    v_and_b32 v91, 0xffff0000, v93
    v_lshlrev_b32 v92, 16, v94
    v_and_b32 v93, 0xffff0000, v94
    v_lshlrev_b32 v94, 16, v95
    v_and_b32 v95, 0xffff0000, v95
    ds_read_b64_tr_b16 v[176:177], v6 offset:49152
    ds_read_b64_tr_b16 v[178:179], v6 offset:50176
    v_mfma_f32_32x32x16_bf16 v[64:79], v[112:115], a[0:3], v[64:79]
    ds_read_b64_tr_b16 v[180:181], v6 offset:53248
    ds_read_b64_tr_b16 v[182:183], v6 offset:54272
    v_lshlrev_b32 v9, 4, v1
    s_lshl_b32 s0, s62, 11
    v_add_u32 v9, s0, v9
    v_xor_b32 v10, 2048, v9
    s_mul_i32 s0, s56, 72
    s_add_u32 s0, s0, s63
    s_add_u32 s0, s0, s58
    s_lshl_b32 s0, s0, 12
    v_mfma_f32_32x32x16_bf16 v[80:95], v[112:115], a[128:131], v[80:95]
    s_add_u32 m0, s60, 0x4000
    s_mul_i32 s65, s84, 114688
    s_add_u32 s65, s65, 256
    buffer_load_dwordx4 v3, s[32:35], s65 offen lds
    ds_read_b64_tr_b16 v[184:185], v6 offset:57344
    s_and_b32 s1, s57, 1
    s_lshl_b32 s1, s1, 2
    s_add_u32 s1, s1, s58
    s_cmp_eq_u32 s1, 4
    s_cselect_b32 s0, 0x4000000, s0
    v_max_f32 v32, 0, v32
    v_max_f32 v33, 0, v33
    v_max_f32 v34, 0, v34
    v_max_f32 v35, 0, v35
    v_max_f32 v36, 0, v36
    v_max_f32 v37, 0, v37
    v_max_f32 v38, 0, v38
    v_mfma_f32_32x32x16_bf16 v[64:79], v[116:119], a[4:7], v[64:79]
    ds_read_b64_tr_b16 v[186:187], v6 offset:58368
    s_add_u32 m0, s60, 0x5000
    s_mul_i32 s65, s84, 114688
    s_add_u32 s65, s65, 57600
    buffer_load_dwordx4 v3, s[32:35], s65 offen lds
    v_max_f32 v39, 0, v39
    v_pk_mul_f32 v[32:33], v[32:33], v[32:33]
    v_pk_mul_f32 v[34:35], v[34:35], v[34:35]
    v_pk_mul_f32 v[36:37], v[36:37], v[36:37]
    v_pk_mul_f32 v[38:39], v[38:39], v[38:39]
    v_cvt_pk_bf16_f32 v32, v32, v33
    v_cvt_pk_bf16_f32 v33, v34, v35
    v_cvt_pk_bf16_f32 v34, v36, v37
    v_mfma_f32_32x32x16_bf16 v[80:95], v[116:119], a[132:135], v[80:95]
    ds_read_b64_tr_b16 v[188:189], v6 offset:61440
    ds_read_b64_tr_b16 v[190:191], v6 offset:62464
    v_cvt_pk_bf16_f32 v35, v38, v39
    buffer_store_dwordx4 v[32:35], v9, s[44:47], s0 offen sc0 sc1
    v_max_f32 v40, 0, v40
    v_max_f32 v41, 0, v41
    v_max_f32 v42, 0, v42
    v_max_f32 v43, 0, v43
    v_max_f32 v44, 0, v44
    v_max_f32 v45, 0, v45
    v_mfma_f32_32x32x16_bf16 v[64:79], v[120:123], a[8:11], v[64:79]
    s_add_u32 m0, s60, 0x6000
    s_mul_i32 s65, s85, 114688
    s_add_u32 s65, s65, 256
    buffer_load_dwordx4 v3, s[32:35], s65 offen lds
    s_add_u32 m0, s60, 0x7000
    s_mul_i32 s65, s85, 114688
    s_add_u32 s65, s65, 57600
    buffer_load_dwordx4 v3, s[32:35], s65 offen lds
    v_max_f32 v46, 0, v46
    v_max_f32 v47, 0, v47
    v_pk_mul_f32 v[40:41], v[40:41], v[40:41]
    v_pk_mul_f32 v[42:43], v[42:43], v[42:43]
    v_pk_mul_f32 v[44:45], v[44:45], v[44:45]
    v_pk_mul_f32 v[46:47], v[46:47], v[46:47]
    v_cvt_pk_bf16_f32 v40, v40, v41
    v_cvt_pk_bf16_f32 v41, v42, v43
    v_mfma_f32_32x32x16_bf16 v[80:95], v[120:123], a[136:139], v[80:95]
    v_cvt_pk_bf16_f32 v42, v44, v45
    v_cvt_pk_bf16_f32 v43, v46, v47
    buffer_store_dwordx4 v[40:43], v9, s[44:47], s0 offen offset:1024 sc0 sc1
    v_max_f32 v48, 0, v48
    v_max_f32 v49, 0, v49
    v_max_f32 v50, 0, v50
    v_max_f32 v51, 0, v51
    v_max_f32 v52, 0, v52
    v_mfma_f32_32x32x16_bf16 v[64:79], v[124:127], a[12:15], v[64:79]
    v_max_f32 v53, 0, v53
    v_max_f32 v54, 0, v54
    v_max_f32 v55, 0, v55
    v_pk_mul_f32 v[48:49], v[48:49], v[48:49]
    v_pk_mul_f32 v[50:51], v[50:51], v[50:51]
    v_pk_mul_f32 v[52:53], v[52:53], v[52:53]
    v_pk_mul_f32 v[54:55], v[54:55], v[54:55]
    v_cvt_pk_bf16_f32 v48, v48, v49
    v_mfma_f32_32x32x16_bf16 v[80:95], v[124:127], a[140:143], v[80:95]
    v_cvt_pk_bf16_f32 v49, v50, v51
    v_cvt_pk_bf16_f32 v50, v52, v53
    v_cvt_pk_bf16_f32 v51, v54, v55
    buffer_store_dwordx4 v[48:51], v10, s[44:47], s0 offen sc0 sc1
    v_max_f32 v56, 0, v56
    v_max_f32 v57, 0, v57
    v_max_f32 v58, 0, v58
    v_max_f32 v59, 0, v59
    s_waitcnt vmcnt(23) lgkmcnt(0)
    s_barrier
    ds_read_b64_tr_b16 v[112:113], v8
    ds_read_b64_tr_b16 v[114:115], v8 offset:1024
    v_mfma_f32_32x32x16_bf16 v[64:79], v[176:179], a[16:19], v[64:79]
    ds_read_b64_tr_b16 v[116:117], v8 offset:4096
    ds_read_b64_tr_b16 v[118:119], v8 offset:5120
    v_max_f32 v60, 0, v60
    v_max_f32 v61, 0, v61
    v_max_f32 v62, 0, v62
    v_max_f32 v63, 0, v63
    v_pk_mul_f32 v[56:57], v[56:57], v[56:57]
    v_pk_mul_f32 v[58:59], v[58:59], v[58:59]
    v_pk_mul_f32 v[60:61], v[60:61], v[60:61]
    v_pk_mul_f32 v[62:63], v[62:63], v[62:63]
    v_mfma_f32_32x32x16_bf16 v[80:95], v[176:179], a[144:147], v[80:95]
    s_add_u32 m0, s60, 0x8000
    s_mul_i32 s65, s70, 98304
    buffer_load_dwordx4 v4, s[28:31], s65 offen lds
    ds_read_b64_tr_b16 v[120:121], v8 offset:8192
    v_cvt_pk_bf16_f32 v56, v56, v57
    v_cvt_pk_bf16_f32 v57, v58, v59
    v_cvt_pk_bf16_f32 v58, v60, v61
    v_cvt_pk_bf16_f32 v59, v62, v63
    buffer_store_dwordx4 v[56:59], v10, s[44:47], s0 offen offset:1024 sc0 sc1
    v_mfma_f32_32x32x16_bf16 v[64:79], v[180:183], a[20:23], v[64:79]
    ds_read_b64_tr_b16 v[122:123], v8 offset:9216
    s_add_u32 m0, s60, 0x9000
    s_mul_i32 s65, s71, 98304
    buffer_load_dwordx4 v4, s[28:31], s65 offen lds
    v_mfma_f32_32x32x16_bf16 v[80:95], v[180:183], a[148:151], v[80:95]
    ds_read_b64_tr_b16 v[124:125], v8 offset:12288
    ds_read_b64_tr_b16 v[126:127], v8 offset:13312
    v_mfma_f32_32x32x16_bf16 v[64:79], v[184:187], a[24:27], v[64:79]
    s_add_u32 m0, s60, 0xa000
    s_mul_i32 s65, s72, 98304
    buffer_load_dwordx4 v4, s[28:31], s65 offen lds
    s_add_u32 m0, s60, 0xb000
    s_mul_i32 s65, s73, 98304
    buffer_load_dwordx4 v4, s[28:31], s65 offen lds
    v_mfma_f32_32x32x16_bf16 v[80:95], v[184:187], a[152:155], v[80:95]
    v_mfma_f32_32x32x16_bf16 v[64:79], v[188:191], a[28:31], v[64:79]
    v_mfma_f32_32x32x16_bf16 v[80:95], v[188:191], a[156:159], v[80:95]
    s_waitcnt lgkmcnt(0)
    ds_read_b64_tr_b16 v[176:177], v8 offset:16384
    ds_read_b64_tr_b16 v[178:179], v8 offset:17408
    v_mfma_f32_32x32x16_bf16 v[64:79], v[112:115], a[32:35], v[64:79]
    ds_read_b64_tr_b16 v[180:181], v8 offset:20480
    ds_read_b64_tr_b16 v[182:183], v8 offset:21504
    v_mfma_f32_32x32x16_bf16 v[80:95], v[112:115], a[160:163], v[80:95]
    s_add_u32 m0, s60, 0xc000
    s_mul_i32 s65, s74, 98304
    buffer_load_dwordx4 v4, s[28:31], s65 offen lds
    ds_read_b64_tr_b16 v[184:185], v8 offset:24576
    v_mfma_f32_32x32x16_bf16 v[64:79], v[116:119], a[36:39], v[64:79]
    ds_read_b64_tr_b16 v[186:187], v8 offset:25600
    s_add_u32 m0, s60, 0xd000
    s_mul_i32 s65, s75, 98304
    buffer_load_dwordx4 v4, s[28:31], s65 offen lds
    v_mfma_f32_32x32x16_bf16 v[80:95], v[116:119], a[164:167], v[80:95]
    ds_read_b64_tr_b16 v[188:189], v8 offset:28672
    ds_read_b64_tr_b16 v[190:191], v8 offset:29696
    v_mfma_f32_32x32x16_bf16 v[64:79], v[120:123], a[40:43], v[64:79]
    s_add_u32 m0, s60, 0xe000
    s_mul_i32 s65, s76, 98304
    buffer_load_dwordx4 v4, s[28:31], s65 offen lds
    s_add_u32 m0, s60, 0xf000
    s_mul_i32 s65, s77, 98304
    buffer_load_dwordx4 v4, s[28:31], s65 offen lds
    v_mfma_f32_32x32x16_bf16 v[80:95], v[120:123], a[168:171], v[80:95]
    v_mfma_f32_32x32x16_bf16 v[64:79], v[124:127], a[44:47], v[64:79]
    v_mfma_f32_32x32x16_bf16 v[80:95], v[124:127], a[172:175], v[80:95]
    s_waitcnt vmcnt(20) lgkmcnt(0)
    s_barrier
    ds_read_b64_tr_b16 v[112:113], v8 offset:32768
    ds_read_b64_tr_b16 v[114:115], v8 offset:33792
    v_mfma_f32_32x32x16_bf16 v[64:79], v[176:179], a[48:51], v[64:79]
    ds_read_b64_tr_b16 v[116:117], v8 offset:36864
    ds_read_b64_tr_b16 v[118:119], v8 offset:37888
    s_cmp_eq_u32 s69, -1
    s_cbranch_scc1 L_nored2
    s_waitcnt vmcnt(20)
    s_mov_b32 s86, 0
L_red_chk:
    v_xor_b32 v9, s64, v147
    v_xor_b32 v10, s64, v151
    v_or_b32 v9, v9, v10
    v_xor_b32 v10, s64, v155
    v_or_b32 v9, v9, v10
    v_xor_b32 v10, s64, v159
    v_or_b32 v9, v9, v10
    v_xor_b32 v10, s64, v163
    v_or_b32 v9, v9, v10
    v_xor_b32 v10, s64, v167
    v_or_b32 v9, v9, v10
    v_xor_b32 v10, s64, v171
    v_or_b32 v9, v9, v10
    v_xor_b32 v10, s64, v175
    v_or_b32 v9, v9, v10
    v_xor_b32 v10, s64, v211
    v_or_b32 v9, v9, v10
    v_xor_b32 v10, s64, v215
    v_or_b32 v9, v9, v10
    v_xor_b32 v10, s64, v219
    v_or_b32 v9, v9, v10
    v_xor_b32 v10, s64, v223
    v_or_b32 v9, v9, v10
    v_cmp_ne_u32 vcc, 0, v9
    s_nop 0
    s_cmp_eq_u64 vcc, 0
    s_cbranch_scc1 L_red_ok
    s_add_u32 s86, s86, 1
    s_cmp_ge_u32 s86, 200000
    s_cbranch_scc1 L_red_ok
    s_sleep 2
    buffer_load_dwordx4 v[144:147], v24, s[44:47], s69 offen sc0 sc1
    buffer_load_dwordx4 v[148:151], v24, s[44:47], s69 offen offset:1024 sc0 sc1
    buffer_load_dwordx4 v[152:155], v24, s[44:47], s69 offen offset:2048 sc0 sc1
    buffer_load_dwordx4 v[156:159], v24, s[44:47], s69 offen offset:3072 sc0 sc1
    buffer_load_dwordx4 v[160:163], v26, s[44:47], s69 offen sc0 sc1
    buffer_load_dwordx4 v[164:167], v26, s[44:47], s69 offen offset:1024 sc0 sc1
    buffer_load_dwordx4 v[168:171], v25, s[44:47], s69 offen sc0 sc1
    buffer_load_dwordx4 v[172:175], v25, s[44:47], s69 offen offset:1024 sc0 sc1
    buffer_load_dwordx4 v[208:211], v25, s[44:47], s69 offen offset:2048 sc0 sc1
    buffer_load_dwordx4 v[212:215], v25, s[44:47], s69 offen offset:3072 sc0 sc1
    buffer_load_dwordx4 v[216:219], v27, s[44:47], s69 offen sc0 sc1
    buffer_load_dwordx4 v[220:223], v27, s[44:47], s69 offen offset:1024 sc0 sc1
    s_waitcnt vmcnt(0)
    s_branch L_red_chk
L_red_ok:
    v_add_f32 v144, v144, v168
    v_add_f32 v145, v145, v169
    v_add_f32 v146, v146, v170
    v_add_f32 v148, v148, v172
    v_add_f32 v149, v149, v173
    v_add_f32 v150, v150, v174
    v_add_f32 v152, v152, v208
    v_add_f32 v153, v153, v209
    v_add_f32 v154, v154, v210
    v_add_f32 v156, v156, v212
    v_add_f32 v157, v157, v213
    v_add_f32 v158, v158, v214
    v_add_f32 v160, v160, v216
    v_add_f32 v161, v161, v217
    v_add_f32 v162, v162, v218
    v_add_f32 v164, v164, v220
    v_add_f32_dpp v144, v144, v144 row_ror:8 row_mask:0xf bank_mask:0xf
    v_add_f32_dpp v145, v145, v145 row_ror:8 row_mask:0xf bank_mask:0xf
    v_add_f32_dpp v146, v146, v146 row_ror:8 row_mask:0xf bank_mask:0xf
    v_add_f32_dpp v148, v148, v148 row_ror:8 row_mask:0xf bank_mask:0xf
    v_add_f32_dpp v149, v149, v149 row_ror:8 row_mask:0xf bank_mask:0xf
    v_add_f32_dpp v150, v150, v150 row_ror:8 row_mask:0xf bank_mask:0xf
    v_add_f32_dpp v152, v152, v152 row_ror:8 row_mask:0xf bank_mask:0xf
    v_add_f32_dpp v153, v153, v153 row_ror:8 row_mask:0xf bank_mask:0xf
    v_add_f32_dpp v154, v154, v154 row_ror:8 row_mask:0xf bank_mask:0xf
    v_add_f32_dpp v156, v156, v156 row_ror:8 row_mask:0xf bank_mask:0xf
    v_add_f32_dpp v157, v157, v157 row_ror:8 row_mask:0xf bank_mask:0xf
    v_add_f32_dpp v158, v158, v158 row_ror:8 row_mask:0xf bank_mask:0xf
    v_add_f32_dpp v160, v160, v160 row_ror:8 row_mask:0xf bank_mask:0xf
    v_add_f32_dpp v161, v161, v161 row_ror:8 row_mask:0xf bank_mask:0xf
    v_add_f32_dpp v162, v162, v162 row_ror:8 row_mask:0xf bank_mask:0xf
    v_add_f32_dpp v164, v164, v164 row_ror:8 row_mask:0xf bank_mask:0xf
    v_add_f32_dpp v144, v144, v144 row_ror:4 row_mask:0xf bank_mask:0xf
    v_add_f32_dpp v145, v145, v145 row_ror:4 row_mask:0xf bank_mask:0xf
    v_add_f32_dpp v146, v146, v146 row_ror:4 row_mask:0xf bank_mask:0xf
    v_add_f32_dpp v148, v148, v148 row_ror:4 row_mask:0xf bank_mask:0xf
    v_add_f32_dpp v149, v149, v149 row_ror:4 row_mask:0xf bank_mask:0xf
    v_add_f32_dpp v150, v150, v150 row_ror:4 row_mask:0xf bank_mask:0xf
    v_add_f32_dpp v152, v152, v152 row_ror:4 row_mask:0xf bank_mask:0xf
    v_add_f32_dpp v153, v153, v153 row_ror:4 row_mask:0xf bank_mask:0xf
    v_add_f32_dpp v154, v154, v154 row_ror:4 row_mask:0xf bank_mask:0xf
    v_add_f32_dpp v156, v156, v156 row_ror:4 row_mask:0xf bank_mask:0xf
    v_add_f32_dpp v157, v157, v157 row_ror:4 row_mask:0xf bank_mask:0xf
    v_add_f32_dpp v158, v158, v158 row_ror:4 row_mask:0xf bank_mask:0xf
    v_add_f32_dpp v160, v160, v160 row_ror:4 row_mask:0xf bank_mask:0xf
    v_add_f32_dpp v161, v161, v161 row_ror:4 row_mask:0xf bank_mask:0xf
    v_add_f32_dpp v162, v162, v162 row_ror:4 row_mask:0xf bank_mask:0xf
    v_add_f32_dpp v164, v164, v164 row_ror:4 row_mask:0xf bank_mask:0xf
    v_mov_b32 v168, v144
    v_mov_b32 v169, v145
    v_mov_b32 v170, v146
    v_mov_b32 v172, v148
    v_mov_b32 v173, v149
    v_mov_b32 v174, v150
    v_mov_b32 v208, v152
    v_mov_b32 v209, v153
    v_mov_b32 v210, v154
    v_mov_b32 v212, v156
    v_mov_b32 v213, v157
    v_mov_b32 v214, v158
    v_mov_b32 v216, v160
    v_mov_b32 v217, v161
    v_mov_b32 v218, v162
    v_mov_b32 v220, v164
    v_permlane16_swap_b32 v144, v168
    v_permlane16_swap_b32 v145, v169
    v_permlane16_swap_b32 v146, v170
    v_permlane16_swap_b32 v148, v172
    v_permlane16_swap_b32 v149, v173
    v_permlane16_swap_b32 v150, v174
    v_permlane16_swap_b32 v152, v208
    v_permlane16_swap_b32 v153, v209
    v_permlane16_swap_b32 v154, v210
    v_permlane16_swap_b32 v156, v212
    v_permlane16_swap_b32 v157, v213
    v_permlane16_swap_b32 v158, v214
    v_permlane16_swap_b32 v160, v216
    v_permlane16_swap_b32 v161, v217
    v_permlane16_swap_b32 v162, v218
    v_permlane16_swap_b32 v164, v220
    v_add_f32 v144, v144, v168
    v_add_f32 v145, v145, v169
    v_add_f32 v146, v146, v170
    v_add_f32 v148, v148, v172
    v_add_f32 v149, v149, v173
    v_add_f32 v150, v150, v174
    v_add_f32 v152, v152, v208
    v_add_f32 v153, v153, v209
    v_add_f32 v154, v154, v210
    v_add_f32 v156, v156, v212
    v_add_f32 v157, v157, v213
    v_add_f32 v158, v158, v214
    v_add_f32 v160, v160, v216
    v_add_f32 v161, v161, v217
    v_add_f32 v162, v162, v218
    v_add_f32 v164, v164, v220
    v_mov_b32 v168, v144
    v_mov_b32 v169, v145
    v_mov_b32 v170, v146
    v_mov_b32 v172, v148
    v_mov_b32 v173, v149
    v_mov_b32 v174, v150
    v_mov_b32 v208, v152
    v_mov_b32 v209, v153
    v_mov_b32 v210, v154
    v_mov_b32 v212, v156
    v_mov_b32 v213, v157
    v_mov_b32 v214, v158
    v_mov_b32 v216, v160
    v_mov_b32 v217, v161
    v_mov_b32 v218, v162
    v_mov_b32 v220, v164
    v_permlane32_swap_b32 v144, v168
    v_permlane32_swap_b32 v145, v169
    v_permlane32_swap_b32 v146, v170
    v_permlane32_swap_b32 v148, v172
    v_permlane32_swap_b32 v149, v173
    v_permlane32_swap_b32 v150, v174
    v_permlane32_swap_b32 v152, v208
    v_permlane32_swap_b32 v153, v209
    v_permlane32_swap_b32 v154, v210
    v_permlane32_swap_b32 v156, v212
    v_permlane32_swap_b32 v157, v213
    v_permlane32_swap_b32 v158, v214
    v_permlane32_swap_b32 v160, v216
    v_permlane32_swap_b32 v161, v217
    v_permlane32_swap_b32 v162, v218
    v_permlane32_swap_b32 v164, v220
    v_add_f32 v144, v144, v168
    v_add_f32 v145, v145, v169
    v_add_f32 v146, v146, v170
    v_add_f32 v148, v148, v172
    v_add_f32 v149, v149, v173
    v_add_f32 v150, v150, v174
    v_add_f32 v152, v152, v208
    v_add_f32 v153, v153, v209
    v_add_f32 v154, v154, v210
    v_add_f32 v156, v156, v212
    v_add_f32 v157, v157, v213
    v_add_f32 v158, v158, v214
    v_add_f32 v160, v160, v216
    v_add_f32 v161, v161, v217
    v_add_f32 v162, v162, v218
    v_add_f32 v164, v164, v220
    v_cvt_pk_bf16_f32 v240, v144, v145
    v_cvt_pk_bf16_f32 v241, v146, v148
    v_cvt_pk_bf16_f32 v242, v149, v150
    v_cvt_pk_bf16_f32 v244, v152, v153
    v_cvt_pk_bf16_f32 v245, v154, v156
    v_cvt_pk_bf16_f32 v246, v157, v158
    v_cvt_pk_bf16_f32 v248, v160, v161
    v_cvt_pk_bf16_f32 v249, v162, v164
    v_mov_b32 v243, s64
    v_mov_b32 v247, s64
    v_mov_b32 v251, s64
    s_lshl_b32 s0, s57, 2
    s_add_u32 s0, s0, s58
    s_mul_i32 s0, s0, 3072
    s_add_u32 s0, s0, s3
    s_add_u32 s0, s0, 0x1800000
    s_mov_b64 exec, 15
    buffer_store_dwordx4 v[240:243], v11, s[44:47], s0 offen sc0 sc1
    buffer_store_dwordx4 v[244:247], v11, s[44:47], s0 offen offset:1024 sc0 sc1
    buffer_store_dwordx4 v[248:251], v11, s[44:47], s0 offen offset:2048 sc0 sc1
    s_mov_b64 exec, -1
    s_nop 1
L_nored2:
    v_mfma_f32_32x32x16_bf16 v[80:95], v[176:179], a[176:179], v[80:95]
    s_add_u32 m0, s60, 0x10000
    s_mul_i32 s65, s78, 98304
    buffer_load_dwordx4 v4, s[28:31], s65 offen lds
    ds_read_b64_tr_b16 v[120:121], v8 offset:40960
    v_mfma_f32_32x32x16_bf16 v[64:79], v[180:183], a[52:55], v[64:79]
    ds_read_b64_tr_b16 v[122:123], v8 offset:41984
    s_add_u32 m0, s60, 0x11000
    s_mul_i32 s65, s79, 98304
    buffer_load_dwordx4 v4, s[28:31], s65 offen lds
    v_mfma_f32_32x32x16_bf16 v[80:95], v[180:183], a[180:183], v[80:95]
    ds_read_b64_tr_b16 v[124:125], v8 offset:45056
    ds_read_b64_tr_b16 v[126:127], v8 offset:46080
    v_mfma_f32_32x32x16_bf16 v[64:79], v[184:187], a[56:59], v[64:79]
    s_add_u32 m0, s60, 0x12000
    s_mul_i32 s65, s80, 98304
    buffer_load_dwordx4 v4, s[28:31], s65 offen lds
    s_add_u32 m0, s60, 0x13000
    s_mul_i32 s65, s81, 98304
    buffer_load_dwordx4 v4, s[28:31], s65 offen lds
    v_mfma_f32_32x32x16_bf16 v[80:95], v[184:187], a[184:187], v[80:95]
    v_mfma_f32_32x32x16_bf16 v[64:79], v[188:191], a[60:63], v[64:79]
    v_mfma_f32_32x32x16_bf16 v[80:95], v[188:191], a[188:191], v[80:95]
    s_waitcnt lgkmcnt(0)
    ds_read_b64_tr_b16 v[176:177], v8 offset:49152
    ds_read_b64_tr_b16 v[178:179], v8 offset:50176
    v_mfma_f32_32x32x16_bf16 v[64:79], v[112:115], a[64:67], v[64:79]
    ds_read_b64_tr_b16 v[180:181], v8 offset:53248
    ds_read_b64_tr_b16 v[182:183], v8 offset:54272
    v_mfma_f32_32x32x16_bf16 v[80:95], v[112:115], a[192:195], v[80:95]
    s_add_u32 m0, s60, 0x14000
    s_mul_i32 s65, s82, 98304
    buffer_load_dwordx4 v4, s[28:31], s65 offen lds
    ds_read_b64_tr_b16 v[184:185], v8 offset:57344
    v_mfma_f32_32x32x16_bf16 v[64:79], v[116:119], a[68:71], v[64:79]
    ds_read_b64_tr_b16 v[186:187], v8 offset:58368
    s_add_u32 m0, s60, 0x15000
    s_mul_i32 s65, s83, 98304
    buffer_load_dwordx4 v4, s[28:31], s65 offen lds
    v_mfma_f32_32x32x16_bf16 v[80:95], v[116:119], a[196:199], v[80:95]
    ds_read_b64_tr_b16 v[188:189], v8 offset:61440
    ds_read_b64_tr_b16 v[190:191], v8 offset:62464
    v_mfma_f32_32x32x16_bf16 v[64:79], v[120:123], a[72:75], v[64:79]
    s_add_u32 m0, s60, 0x16000
    s_mul_i32 s65, s84, 98304
    buffer_load_dwordx4 v4, s[28:31], s65 offen lds
    s_add_u32 m0, s60, 0x17000
    s_mul_i32 s65, s85, 98304
    buffer_load_dwordx4 v4, s[28:31], s65 offen lds
    v_mfma_f32_32x32x16_bf16 v[80:95], v[120:123], a[200:203], v[80:95]
    v_mfma_f32_32x32x16_bf16 v[64:79], v[124:127], a[76:79], v[64:79]
    v_mfma_f32_32x32x16_bf16 v[80:95], v[124:127], a[204:207], v[80:95]
    s_waitcnt vmcnt(19) lgkmcnt(0)
    s_barrier
    ds_read_b64_tr_b16 v[112:113], v6
    ds_read_b64_tr_b16 v[114:115], v6 offset:1024
    v_mfma_f32_32x32x16_bf16 v[64:79], v[176:179], a[80:83], v[64:79]
    ds_read_b64_tr_b16 v[116:117], v6 offset:4096
    ds_read_b64_tr_b16 v[118:119], v6 offset:5120
    v_mfma_f32_32x32x16_bf16 v[80:95], v[176:179], a[208:211], v[80:95]
    s_lshl_b32 s66, s60, 3
    s_add_u32 m0, s66, 0x18000
    s_lshl_b32 s65, s4, 15
    buffer_load_dwordx4 v2, s[48:51], s65 offen lds
    ds_read_b64_tr_b16 v[120:121], v6 offset:8192
    v_mfma_f32_32x32x16_bf16 v[64:79], v[180:183], a[84:87], v[64:79]
    ds_read_b64_tr_b16 v[122:123], v6 offset:9216
    s_lshl_b32 s66, s60, 3
    s_add_u32 m0, s66, 0x18400
    s_lshl_b32 s65, s4, 15
    s_add_u32 s65, s65, 8192
    buffer_load_dwordx4 v2, s[48:51], s65 offen lds
    v_mfma_f32_32x32x16_bf16 v[80:95], v[180:183], a[212:215], v[80:95]
    ds_read_b64_tr_b16 v[124:125], v6 offset:12288
    ds_read_b64_tr_b16 v[126:127], v6 offset:13312
    v_mfma_f32_32x32x16_bf16 v[64:79], v[184:187], a[88:91], v[64:79]
    s_lshl_b32 s66, s60, 3
    s_add_u32 m0, s66, 0x18800
    s_lshl_b32 s65, s4, 15
    s_add_u32 s65, s65, 16384
    buffer_load_dwordx4 v2, s[48:51], s65 offen lds
    s_lshl_b32 s66, s60, 3
    s_add_u32 m0, s66, 0x18c00
    s_lshl_b32 s65, s4, 15
    s_add_u32 s65, s65, 24576
    buffer_load_dwordx4 v2, s[48:51], s65 offen lds
    v_mfma_f32_32x32x16_bf16 v[80:95], v[184:187], a[216:219], v[80:95]
    v_mfma_f32_32x32x16_bf16 v[64:79], v[188:191], a[92:95], v[64:79]
    v_mfma_f32_32x32x16_bf16 v[80:95], v[188:191], a[220:223], v[80:95]
    s_waitcnt lgkmcnt(0)
    ds_read_b64_tr_b16 v[176:177], v6 offset:16384
    ds_read_b64_tr_b16 v[178:179], v6 offset:17408
    v_mfma_f32_32x32x16_bf16 v[64:79], v[112:115], a[96:99], v[64:79]
    ds_read_b64_tr_b16 v[180:181], v6 offset:20480
    ds_read_b64_tr_b16 v[182:183], v6 offset:21504
    v_mfma_f32_32x32x16_bf16 v[80:95], v[112:115], a[224:227], v[80:95]
    s_lshl_b32 s66, s60, 3
    s_add_u32 m0, s66, 0x19000
    s_lshl_b32 s65, s5, 15
    buffer_load_dwordx4 v2, s[48:51], s65 offen lds
    ds_read_b64_tr_b16 v[184:185], v6 offset:24576
    v_mfma_f32_32x32x16_bf16 v[64:79], v[116:119], a[100:103], v[64:79]
    ds_read_b64_tr_b16 v[186:187], v6 offset:25600
    s_lshl_b32 s66, s60, 3
    s_add_u32 m0, s66, 0x19400
    s_lshl_b32 s65, s5, 15
    s_add_u32 s65, s65, 8192
    buffer_load_dwordx4 v2, s[48:51], s65 offen lds
    v_mfma_f32_32x32x16_bf16 v[80:95], v[116:119], a[228:231], v[80:95]
    ds_read_b64_tr_b16 v[188:189], v6 offset:28672
    ds_read_b64_tr_b16 v[190:191], v6 offset:29696
    v_mfma_f32_32x32x16_bf16 v[64:79], v[120:123], a[104:107], v[64:79]
    s_lshl_b32 s66, s60, 3
    s_add_u32 m0, s66, 0x19800
    s_lshl_b32 s65, s5, 15
    s_add_u32 s65, s65, 16384
    buffer_load_dwordx4 v2, s[48:51], s65 offen lds
    s_lshl_b32 s66, s60, 3
    s_add_u32 m0, s66, 0x19c00
    s_lshl_b32 s65, s5, 15
    s_add_u32 s65, s65, 24576
    buffer_load_dwordx4 v2, s[48:51], s65 offen lds
    v_mfma_f32_32x32x16_bf16 v[80:95], v[120:123], a[232:235], v[80:95]
    v_mfma_f32_32x32x16_bf16 v[64:79], v[124:127], a[108:111], v[64:79]
    v_mfma_f32_32x32x16_bf16 v[80:95], v[124:127], a[236:239], v[80:95]
    s_waitcnt vmcnt(16) lgkmcnt(0)
    s_barrier
    ds_read_b64_tr_b16 v[112:113], v7 offset:32768
    ds_read_b64_tr_b16 v[114:115], v7 offset:33280
    v_mfma_f32_32x32x16_bf16 v[64:79], v[176:179], a[112:115], v[64:79]
    ds_read_b64_tr_b16 v[116:117], v7 offset:34816
    ds_read_b64_tr_b16 v[118:119], v7 offset:35328
    s_lshl_b32 s66, s60, 3
    s_add_u32 m0, s66, 0x0
    s_lshl_b32 s65, s6, 15
    buffer_load_dwordx4 v2, s[48:51], s65 offen lds
    s_waitcnt vmcnt(24)
    s_lshl_b32 s0, s56, 7
    s_lshl_b32 s1, s57, 4
    s_add_u32 s0, s0, s1
    s_lshl_b32 s1, s58, 2
    s_add_u32 s0, s0, s1
    s_add_u32 s0, s0, 0x1a04000
    v_mov_b32 v9, 0
    v_mov_b32 v10, s64
    s_mov_b64 exec, 1
    buffer_store_dword v10, v9, s[44:47], s0 offen sc0 sc1
    s_mov_b64 exec, -1
    v_mfma_f32_32x32x16_bf16 v[80:95], v[176:179], a[240:243], v[80:95]
    ds_read_b64_tr_b16 v[120:121], v7 offset:36864
    ds_read_b64_tr_b16 v[122:123], v7 offset:37376
    s_lshl_b32 s66, s60, 3
    s_add_u32 m0, s66, 0x400
    s_lshl_b32 s65, s6, 15
    s_add_u32 s65, s65, 8192
    buffer_load_dwordx4 v2, s[48:51], s65 offen lds
    v_mfma_f32_32x32x16_bf16 v[64:79], v[180:183], a[116:119], v[64:79]
    ds_read_b64_tr_b16 v[124:125], v7 offset:38912
    ds_read_b64_tr_b16 v[126:127], v7 offset:39424
    s_lshl_b32 s66, s60, 3
    s_add_u32 m0, s66, 0x800
    s_lshl_b32 s65, s6, 15
    s_add_u32 s65, s65, 16384
    buffer_load_dwordx4 v2, s[48:51], s65 offen lds
    v_mfma_f32_32x32x16_bf16 v[80:95], v[180:183], a[244:247], v[80:95]
    ds_read_b64_tr_b16 v[128:129], v7 offset:40960
    ds_read_b64_tr_b16 v[130:131], v7 offset:41472
    s_lshl_b32 s66, s60, 3
    s_add_u32 m0, s66, 0xc00
    s_lshl_b32 s65, s6, 15
    s_add_u32 s65, s65, 24576
    buffer_load_dwordx4 v2, s[48:51], s65 offen lds
    v_mfma_f32_32x32x16_bf16 v[64:79], v[184:187], a[120:123], v[64:79]
    ds_read_b64_tr_b16 v[132:133], v7 offset:43008
    ds_read_b64_tr_b16 v[134:135], v7 offset:43520
    ds_read_b64_tr_b16 v[136:137], v7 offset:45056
    v_mfma_f32_32x32x16_bf16 v[80:95], v[184:187], a[248:251], v[80:95]
    ds_read_b64_tr_b16 v[138:139], v7 offset:45568
    ds_read_b64_tr_b16 v[140:141], v7 offset:47104
    ds_read_b64_tr_b16 v[142:143], v7 offset:47616
    v_mfma_f32_32x32x16_bf16 v[64:79], v[188:191], a[124:127], v[64:79]
    v_mfma_f32_32x32x16_bf16 v[80:95], v[188:191], a[252:255], v[80:95]
    s_waitcnt lgkmcnt(0)
    ds_read_b64_tr_b16 v[176:177], v7 offset:49152
    ds_read_b64_tr_b16 v[178:179], v7 offset:49664
    v_mfma_f32_32x32x16_bf16 v[96:111], v[112:115], a[0:3], 0
    ds_read_b64_tr_b16 v[180:181], v7 offset:51200
    ds_read_b64_tr_b16 v[182:183], v7 offset:51712
    s_lshl_b32 s66, s60, 3
    s_add_u32 m0, s66, 0x1000
    s_lshl_b32 s65, s7, 15
    buffer_load_dwordx4 v2, s[48:51], s65 offen lds
    v_lshlrev_b32 v9, 4, v1
    s_lshl_b32 s0, s62, 11
    v_add_u32 v9, s0, v9
    v_xor_b32 v10, 2048, v9
    s_mul_i32 s0, s56, 72
    s_add_u32 s0, s0, s63
    s_add_u32 s0, s0, s58
    s_add_u32 s0, s0, 4
    v_mfma_f32_32x32x16_bf16 v[96:111], v[116:119], a[4:7], v[96:111]
    ds_read_b64_tr_b16 v[184:185], v7 offset:53248
    ds_read_b64_tr_b16 v[186:187], v7 offset:53760
    s_lshl_b32 s66, s60, 3
    s_add_u32 m0, s66, 0x1400
    s_lshl_b32 s65, s7, 15
    s_add_u32 s65, s65, 8192
    buffer_load_dwordx4 v2, s[48:51], s65 offen lds
    s_lshl_b32 s0, s0, 12
    s_and_b32 s1, s57, 1
    s_lshl_b32 s1, s1, 2
    s_add_u32 s1, s1, s58
    s_cmp_eq_u32 s1, 3
    s_cselect_b32 s0, 0x4000000, s0
    v_max_f32 v64, 0, v64
    v_max_f32 v65, 0, v65
    v_max_f32 v66, 0, v66
    v_max_f32 v67, 0, v67
    v_max_f32 v68, 0, v68
    v_max_f32 v69, 0, v69
    v_mfma_f32_32x32x16_bf16 v[96:111], v[120:123], a[8:11], v[96:111]
    ds_read_b64_tr_b16 v[188:189], v7 offset:55296
    ds_read_b64_tr_b16 v[190:191], v7 offset:55808
    s_lshl_b32 s66, s60, 3
    s_add_u32 m0, s66, 0x1800
    s_lshl_b32 s65, s7, 15
    s_add_u32 s65, s65, 16384
    buffer_load_dwordx4 v2, s[48:51], s65 offen lds
    v_max_f32 v70, 0, v70
    v_max_f32 v71, 0, v71
    v_pk_mul_f32 v[64:65], v[64:65], v[64:65]
    v_pk_mul_f32 v[66:67], v[66:67], v[66:67]
    v_pk_mul_f32 v[68:69], v[68:69], v[68:69]
    v_pk_mul_f32 v[70:71], v[70:71], v[70:71]
    v_cvt_pk_bf16_f32 v64, v64, v65
    v_cvt_pk_bf16_f32 v65, v66, v67
    v_mfma_f32_32x32x16_bf16 v[96:111], v[124:127], a[12:15], v[96:111]
    ds_read_b64_tr_b16 v[192:193], v7 offset:57344
    ds_read_b64_tr_b16 v[194:195], v7 offset:57856
    s_lshl_b32 s66, s60, 3
    s_add_u32 m0, s66, 0x1c00
    s_lshl_b32 s65, s7, 15
    s_add_u32 s65, s65, 24576
    buffer_load_dwordx4 v2, s[48:51], s65 offen lds
    v_cvt_pk_bf16_f32 v66, v68, v69
    v_cvt_pk_bf16_f32 v67, v70, v71
    buffer_store_dwordx4 v[64:67], v9, s[44:47], s0 offen sc0 sc1
    v_max_f32 v72, 0, v72
    v_max_f32 v73, 0, v73
    v_max_f32 v74, 0, v74
    v_max_f32 v75, 0, v75
    v_max_f32 v76, 0, v76
    v_mfma_f32_32x32x16_bf16 v[96:111], v[128:131], a[16:19], v[96:111]
    ds_read_b64_tr_b16 v[196:197], v7 offset:59392
    ds_read_b64_tr_b16 v[198:199], v7 offset:59904
    ds_read_b64_tr_b16 v[200:201], v7 offset:61440
    v_max_f32 v77, 0, v77
    v_max_f32 v78, 0, v78
    v_max_f32 v79, 0, v79
    v_pk_mul_f32 v[72:73], v[72:73], v[72:73]
    v_pk_mul_f32 v[74:75], v[74:75], v[74:75]
    v_pk_mul_f32 v[76:77], v[76:77], v[76:77]
    v_pk_mul_f32 v[78:79], v[78:79], v[78:79]
    v_cvt_pk_bf16_f32 v72, v72, v73
    v_mfma_f32_32x32x16_bf16 v[96:111], v[132:135], a[20:23], v[96:111]
    ds_read_b64_tr_b16 v[202:203], v7 offset:61952
    ds_read_b64_tr_b16 v[204:205], v7 offset:63488
    ds_read_b64_tr_b16 v[206:207], v7 offset:64000
    v_cvt_pk_bf16_f32 v73, v74, v75
    v_cvt_pk_bf16_f32 v74, v76, v77
    v_cvt_pk_bf16_f32 v75, v78, v79
    buffer_store_dwordx4 v[72:75], v9, s[44:47], s0 offen offset:1024 sc0 sc1
    v_max_f32 v80, 0, v80
    v_max_f32 v81, 0, v81
    v_max_f32 v82, 0, v82
    v_max_f32 v83, 0, v83
    v_mfma_f32_32x32x16_bf16 v[96:111], v[136:139], a[24:27], v[96:111]
    v_max_f32 v84, 0, v84
    v_max_f32 v85, 0, v85
    v_max_f32 v86, 0, v86
    v_max_f32 v87, 0, v87
    v_pk_mul_f32 v[80:81], v[80:81], v[80:81]
    v_pk_mul_f32 v[82:83], v[82:83], v[82:83]
    v_pk_mul_f32 v[84:85], v[84:85], v[84:85]
    v_pk_mul_f32 v[86:87], v[86:87], v[86:87]
    v_mfma_f32_32x32x16_bf16 v[96:111], v[140:143], a[28:31], v[96:111]
    v_cvt_pk_bf16_f32 v80, v80, v81
    v_cvt_pk_bf16_f32 v81, v82, v83
    v_cvt_pk_bf16_f32 v82, v84, v85
    v_cvt_pk_bf16_f32 v83, v86, v87
    buffer_store_dwordx4 v[80:83], v10, s[44:47], s0 offen sc0 sc1
    v_max_f32 v88, 0, v88
    v_max_f32 v89, 0, v89
    v_max_f32 v90, 0, v90
    s_waitcnt vmcnt(20) lgkmcnt(0)
    s_barrier
    v_add_u32 v8, 0x10000, v7
    ds_read_b64_tr_b16 v[112:113], v8
    ds_read_b64_tr_b16 v[114:115], v8 offset:512
    v_mfma_f32_32x32x16_bf16 v[96:111], v[176:179], a[32:35], v[96:111]
    ds_read_b64_tr_b16 v[116:117], v8 offset:2048
    ds_read_b64_tr_b16 v[118:119], v8 offset:2560
    s_lshl_b32 s66, s60, 3
    s_add_u32 m0, s66, 0x8000
    s_lshl_b32 s65, s8, 15
    buffer_load_dwordx4 v2, s[48:51], s65 offen lds
    v_max_f32 v91, 0, v91
    v_max_f32 v92, 0, v92
    v_max_f32 v93, 0, v93
    v_max_f32 v94, 0, v94
    v_max_f32 v95, 0, v95
    v_pk_mul_f32 v[88:89], v[88:89], v[88:89]
    v_pk_mul_f32 v[90:91], v[90:91], v[90:91]
    v_pk_mul_f32 v[92:93], v[92:93], v[92:93]
    v_mfma_f32_32x32x16_bf16 v[96:111], v[180:183], a[36:39], v[96:111]
    ds_read_b64_tr_b16 v[120:121], v8 offset:4096
    ds_read_b64_tr_b16 v[122:123], v8 offset:4608
    s_lshl_b32 s66, s60, 3
    s_add_u32 m0, s66, 0x8400
    s_lshl_b32 s65, s8, 15
    s_add_u32 s65, s65, 8192
    buffer_load_dwordx4 v2, s[48:51], s65 offen lds
    v_pk_mul_f32 v[94:95], v[94:95], v[94:95]
    v_cvt_pk_bf16_f32 v88, v88, v89
    v_cvt_pk_bf16_f32 v89, v90, v91
    v_cvt_pk_bf16_f32 v90, v92, v93
    v_cvt_pk_bf16_f32 v91, v94, v95
    buffer_store_dwordx4 v[88:91], v10, s[44:47], s0 offen offset:1024 sc0 sc1
    v_lshlrev_b32 v5, 4, v1
    v_mfma_f32_32x32x16_bf16 v[96:111], v[184:187], a[40:43], v[96:111]
    ds_read_b64_tr_b16 v[124:125], v8 offset:6144
    ds_read_b64_tr_b16 v[126:127], v8 offset:6656
    s_lshl_b32 s66, s60, 3
    s_add_u32 m0, s66, 0x8800
    s_lshl_b32 s65, s8, 15
    s_add_u32 s65, s65, 16384
    buffer_load_dwordx4 v2, s[48:51], s65 offen lds
    v_and_b32 v6, 7, v1
    v_lshlrev_b32 v6, 2, v6
    v_and_b32 v24, 31, v1
    v_min_u32 v24, 16, v24
    v_and_b32 v9, 32, v1
    v_add_u32 v24, v24, v9
    v_lshlrev_b32 v24, 4, v24
    v_mfma_f32_32x32x16_bf16 v[96:111], v[188:191], a[44:47], v[96:111]
    ds_read_b64_tr_b16 v[128:129], v8 offset:8192
    ds_read_b64_tr_b16 v[130:131], v8 offset:8704
    s_lshl_b32 s66, s60, 3
    s_add_u32 m0, s66, 0x8c00
    s_lshl_b32 s65, s8, 15
    s_add_u32 s65, s65, 24576
    buffer_load_dwordx4 v2, s[48:51], s65 offen lds
    v_mfma_f32_32x32x16_bf16 v[96:111], v[192:195], a[48:51], v[96:111]
    ds_read_b64_tr_b16 v[132:133], v8 offset:10240
    ds_read_b64_tr_b16 v[134:135], v8 offset:10752
    ds_read_b64_tr_b16 v[136:137], v8 offset:12288
    v_mfma_f32_32x32x16_bf16 v[96:111], v[196:199], a[52:55], v[96:111]
    ds_read_b64_tr_b16 v[138:139], v8 offset:12800
    ds_read_b64_tr_b16 v[140:141], v8 offset:14336
    ds_read_b64_tr_b16 v[142:143], v8 offset:14848
    v_mfma_f32_32x32x16_bf16 v[96:111], v[200:203], a[56:59], v[96:111]
    v_mfma_f32_32x32x16_bf16 v[96:111], v[204:207], a[60:63], v[96:111]
    s_waitcnt lgkmcnt(0)
    ds_read_b64_tr_b16 v[176:177], v8 offset:16384
    ds_read_b64_tr_b16 v[178:179], v8 offset:16896
    v_mfma_f32_32x32x16_bf16 v[96:111], v[112:115], a[64:67], v[96:111]
    ds_read_b64_tr_b16 v[180:181], v8 offset:18432
    ds_read_b64_tr_b16 v[182:183], v8 offset:18944
    s_lshl_b32 s66, s60, 3
    s_add_u32 m0, s66, 0x9000
    s_lshl_b32 s65, s9, 15
    buffer_load_dwordx4 v2, s[48:51], s65 offen lds
    s_lshl_b32 s65, s56, 7
    s_lshl_b32 s66, s58, 5
    s_add_u32 s65, s65, s66
    s_add_u32 s65, s65, 0x1a04000
    buffer_load_dword v25, v6, s[44:47], s65 offen sc0 sc1
    v_mfma_f32_32x32x16_bf16 v[96:111], v[116:119], a[68:71], v[96:111]
    ds_read_b64_tr_b16 v[184:185], v8 offset:20480
    ds_read_b64_tr_b16 v[186:187], v8 offset:20992
    s_lshl_b32 s66, s60, 3
    s_add_u32 m0, s66, 0x9400
    s_lshl_b32 s65, s9, 15
    s_add_u32 s65, s65, 8192
    buffer_load_dwordx4 v2, s[48:51], s65 offen lds
    v_mfma_f32_32x32x16_bf16 v[96:111], v[120:123], a[72:75], v[96:111]
    ds_read_b64_tr_b16 v[188:189], v8 offset:22528
    ds_read_b64_tr_b16 v[190:191], v8 offset:23040
    s_lshl_b32 s66, s60, 3
    s_add_u32 m0, s66, 0x9800
    s_lshl_b32 s65, s9, 15
    s_add_u32 s65, s65, 16384
    buffer_load_dwordx4 v2, s[48:51], s65 offen lds
    v_mfma_f32_32x32x16_bf16 v[96:111], v[124:127], a[76:79], v[96:111]
    ds_read_b64_tr_b16 v[192:193], v8 offset:24576
    ds_read_b64_tr_b16 v[194:195], v8 offset:25088
    s_lshl_b32 s66, s60, 3
    s_add_u32 m0, s66, 0x9c00
    s_lshl_b32 s65, s9, 15
    s_add_u32 s65, s65, 24576
    buffer_load_dwordx4 v2, s[48:51], s65 offen lds
    v_mfma_f32_32x32x16_bf16 v[96:111], v[128:131], a[80:83], v[96:111]
    ds_read_b64_tr_b16 v[196:197], v8 offset:26624
    ds_read_b64_tr_b16 v[198:199], v8 offset:27136
    ds_read_b64_tr_b16 v[200:201], v8 offset:28672
    v_mfma_f32_32x32x16_bf16 v[96:111], v[132:135], a[84:87], v[96:111]
    ds_read_b64_tr_b16 v[202:203], v8 offset:29184
    ds_read_b64_tr_b16 v[204:205], v8 offset:30720
    ds_read_b64_tr_b16 v[206:207], v8 offset:31232
    v_mfma_f32_32x32x16_bf16 v[96:111], v[136:139], a[88:91], v[96:111]
    v_mfma_f32_32x32x16_bf16 v[96:111], v[140:143], a[92:95], v[96:111]
    s_waitcnt lgkmcnt(0)
    s_barrier
    v_mfma_f32_32x32x16_bf16 v[96:111], v[176:179], a[96:99], v[96:111]
    s_lshl_b32 s66, s60, 3
    s_add_u32 m0, s66, 0x10000
    s_lshl_b32 s65, s10, 15
    buffer_load_dwordx4 v2, s[48:51], s65 offen lds
    v_mfma_f32_32x32x16_bf16 v[96:111], v[180:183], a[100:103], v[96:111]
    s_lshl_b32 s66, s60, 3
    s_add_u32 m0, s66, 0x10400
    s_lshl_b32 s65, s10, 15
    s_add_u32 s65, s65, 8192
    buffer_load_dwordx4 v2, s[48:51], s65 offen lds
    v_mfma_f32_32x32x16_bf16 v[96:111], v[184:187], a[104:107], v[96:111]
    s_lshl_b32 s66, s60, 3
    s_add_u32 m0, s66, 0x10800
    s_lshl_b32 s65, s10, 15
    s_add_u32 s65, s65, 16384
    buffer_load_dwordx4 v2, s[48:51], s65 offen lds
    v_mfma_f32_32x32x16_bf16 v[96:111], v[188:191], a[108:111], v[96:111]
    s_lshl_b32 s66, s60, 3
    s_add_u32 m0, s66, 0x10c00
    s_lshl_b32 s65, s10, 15
    s_add_u32 s65, s65, 24576
    buffer_load_dwordx4 v2, s[48:51], s65 offen lds
    v_mfma_f32_32x32x16_bf16 v[96:111], v[192:195], a[112:115], v[96:111]
    s_lshl_b32 s66, s60, 3
    s_add_u32 m0, s66, 0x11000
    s_lshl_b32 s65, s11, 15
    buffer_load_dwordx4 v2, s[48:51], s65 offen lds
    v_mfma_f32_32x32x16_bf16 v[96:111], v[196:199], a[116:119], v[96:111]
    s_lshl_b32 s66, s60, 3
    s_add_u32 m0, s66, 0x11400
    s_lshl_b32 s65, s11, 15
    s_add_u32 s65, s65, 8192
    buffer_load_dwordx4 v2, s[48:51], s65 offen lds
    v_mfma_f32_32x32x16_bf16 v[96:111], v[200:203], a[120:123], v[96:111]
    s_lshl_b32 s66, s60, 3
    s_add_u32 m0, s66, 0x11800
    s_lshl_b32 s65, s11, 15
    s_add_u32 s65, s65, 16384
    buffer_load_dwordx4 v2, s[48:51], s65 offen lds
    v_mfma_f32_32x32x16_bf16 v[96:111], v[204:207], a[124:127], v[96:111]
    s_lshl_b32 s66, s60, 3
    s_add_u32 m0, s66, 0x11c00
    s_lshl_b32 s65, s11, 15
    s_add_u32 s65, s65, 24576
    buffer_load_dwordx4 v2, s[48:51], s65 offen lds
    s_setprio 3
    s_nop 5
    v_cvt_pk_bf16_f32 v128, v96, v97
    v_cvt_pk_bf16_f32 v129, v98, v99
    v_cvt_pk_bf16_f32 v130, v100, v101
    v_cvt_pk_bf16_f32 v131, v102, v103
    v_cvt_pk_bf16_f32 v132, v104, v105
    v_cvt_pk_bf16_f32 v133, v106, v107
    v_cvt_pk_bf16_f32 v134, v108, v109
    v_cvt_pk_bf16_f32 v135, v110, v111
    s_mul_i32 s67, s56, 294912
    v_add_u32 v3, s67, v5
    s_waitcnt vmcnt(11)
    s_mov_b32 s86, 0
L_ha_chk:
    v_xor_b32 v29, s64, v25
    v_cmp_ne_u32 vcc, 0, v29
    s_nop 0
    s_cmp_eq_u64 vcc, 0
    s_cbranch_scc1 L_ha_ok
    s_add_u32 s86, s86, 1
    s_cmp_ge_u32 s86, 200000
    s_cbranch_scc1 L_ha_ok
    s_sleep 2
    s_lshl_b32 s65, s56, 7
    s_lshl_b32 s66, s58, 5
    s_add_u32 s65, s65, s66
    s_add_u32 s65, s65, 0x1a04000
    buffer_load_dword v25, v6, s[44:47], s65 offen sc0 sc1
    s_waitcnt vmcnt(0)
    s_branch L_ha_chk
L_ha_ok:
    s_lshl_b32 s66, s4, 12
    buffer_load_dwordx4 a[0:3], v3, s[44:47], s66 offen sc0 sc1
    s_lshl_b32 s66, s4, 12
    buffer_load_dwordx4 a[4:7], v3, s[44:47], s66 offen offset:1024 sc0 sc1
    s_lshl_b32 s66, s4, 12
    buffer_load_dwordx4 a[8:11], v3, s[44:47], s66 offen offset:2048 sc0 sc1
    s_lshl_b32 s66, s4, 12
    buffer_load_dwordx4 a[12:15], v3, s[44:47], s66 offen offset:3072 sc0 sc1
    v_and_b32 v30, 15, v1
    v_lshrrev_b32 v31, 2, v30
    v_lshrrev_b32 v29, 5, v1
    v_lshl_add_u32 v8, v29, 2, v31
    v_and_b32 v31, 2, v31
    v_lshrrev_b32 v29, 4, v1
    v_and_b32 v29, 1, v29
    v_or_b32 v31, v31, v29
    v_and_b32 v30, 3, v30
    v_lshlrev_b32 v30, 3, v30
    v_lshl_add_u32 v30, v31, 5, v30
    v_lshl_add_u32 v30, v8, 7, v30
    s_lshl_b32 s0, s60, 3
    v_add_u32 v12, s0, v30
    v_xor_b32 v13, 64, v12
    v_add_u32 v14, 0x10000, v12
    v_add_u32 v15, 0x10000, v13
    s_waitcnt vmcnt(19)
    s_lshl_b32 s65, s56, 7
    s_lshl_b32 s66, s57, 4
    s_add_u32 s65, s65, s66
    s_lshl_b32 s66, s58, 2
    s_add_u32 s65, s65, s66
    s_add_u32 s65, s65, 0x1a08000
    v_mov_b32 v29, 0
    v_mov_b32 v30, s64
    s_mov_b64 exec, 1
    buffer_store_dword v30, v29, s[44:47], s65 offen sc0 sc1
    s_mov_b64 exec, -1
    s_lshl_b32 s0, s57, 2
    s_lshl_b32 s1, s61, 1
    s_add_u32 s0, s0, s1
    s_mul_i32 s0, s0, 3072
    s_add_u32 s0, s0, 0x1800000
    s_add_u32 s1, s0, 3072
    buffer_load_dwordx4 v[188:191], v24, s[44:47], s0 offen sc0 sc1
    buffer_load_dwordx4 v[192:195], v24, s[44:47], s0 offen offset:1024 sc0 sc1
    buffer_load_dwordx4 v[196:199], v24, s[44:47], s0 offen offset:2048 sc0 sc1
    buffer_load_dwordx4 v[200:203], v24, s[44:47], s1 offen sc0 sc1
    buffer_load_dwordx4 v[204:207], v24, s[44:47], s1 offen offset:1024 sc0 sc1
    buffer_load_dwordx4 v[208:211], v24, s[44:47], s1 offen offset:2048 sc0 sc1
    v_mov_b32 v10, 0x3fb8aa3b
    v_mfma_f32_32x32x16_bf16 v[136:151], v[16:19], v[128:131], 0
    v_mov_b32 v170, 0
    v_mov_b32 v170, 0
    v_mov_b32 v170, 0
    v_mov_b32 v170, 0
    v_mov_b32 v170, 0
    v_mov_b32 v170, 0
    v_mov_b32 v170, 0
    v_mov_b32 v170, 0
    s_lshl_b32 s66, s5, 12
    buffer_load_dwordx4 a[16:19], v3, s[44:47], s66 offen sc0 sc1
    s_nop 1
    v_cvt_pk_bf16_f32 v152, v136, v137
    v_cvt_pk_bf16_f32 v153, v138, v139
    v_cvt_pk_bf16_f32 v154, v140, v141
    v_cvt_pk_bf16_f32 v155, v142, v143
    v_lshlrev_b32 v136, 16, v152
    v_and_b32 v137, 0xffff0000, v152
    v_lshlrev_b32 v138, 16, v153
    v_and_b32 v139, 0xffff0000, v153
    v_lshlrev_b32 v140, 16, v154
    v_and_b32 v141, 0xffff0000, v154
    s_lshl_b32 s66, s5, 12
    buffer_load_dwordx4 a[20:23], v3, s[44:47], s66 offen offset:1024 sc0 sc1
    v_lshlrev_b32 v142, 16, v155
    v_and_b32 v143, 0xffff0000, v155
    v_max3_f32 v168, v136, v137, v138
    v_max3_f32 v152, v139, v140, v141
    v_max3_f32 v169, -v136, -v137, -v138
    v_max3_f32 v153, -v139, -v140, -v141
    v_max3_f32 v168, v168, v142, v143
    v_max3_f32 v169, v169, -v142, -v143
    v_max_f32 v168, v168, v152
    v_max_f32 v169, v169, v153
    s_lshl_b32 s66, s5, 12
    buffer_load_dwordx4 a[24:27], v3, s[44:47], s66 offen offset:2048 sc0 sc1
    v_mov_b32 v170, 0
    v_permlane32_swap_b32 v168, v169
    v_max_f32 v168, v168, v169
    v_mul_f32 v168, 0x3fb8aa3b, v168
    v_mov_b32 v169, v168
    v_mov_b32 v170, 0
    s_nop 0
    v_permlane32_swap_b32 v168, v169
    v_fma_f32 v152, v136, v10, -v168
    v_fma_f32 v153, v137, v10, -v168
    v_fma_f32 v154, v138, v10, -v168
    s_lshl_b32 s66, s5, 12
    buffer_load_dwordx4 a[28:31], v3, s[44:47], s66 offen offset:3072 sc0 sc1
    v_fma_f32 v155, v139, v10, -v168
    v_fma_f32 v156, v140, v10, -v168
    v_fma_f32 v157, v141, v10, -v168
    v_fma_f32 v158, v142, v10, -v168
    v_fma_f32 v159, v143, v10, -v168
    v_fma_f32 v160, -v136, v10, -v169
    v_fma_f32 v161, -v137, v10, -v169
    v_fma_f32 v162, -v138, v10, -v169
    v_fma_f32 v163, -v139, v10, -v169
    v_fma_f32 v164, -v140, v10, -v169
    s_lshl_b32 s66, s6, 12
    buffer_load_dwordx4 a[32:35], v3, s[44:47], s66 offen sc0 sc1
    v_fma_f32 v165, -v141, v10, -v169
    v_fma_f32 v166, -v142, v10, -v169
    v_fma_f32 v167, -v143, v10, -v169
    v_exp_f32 v152, v152
    v_exp_f32 v153, v153
    v_exp_f32 v154, v154
    v_exp_f32 v155, v155
    v_exp_f32 v156, v156
    v_exp_f32 v157, v157
    v_exp_f32 v158, v158
    s_lshl_b32 s66, s6, 12
    buffer_load_dwordx4 a[36:39], v3, s[44:47], s66 offen offset:1024 sc0 sc1
    v_exp_f32 v159, v159
    v_exp_f32 v160, v160
    v_exp_f32 v161, v161
    v_exp_f32 v162, v162
    v_exp_f32 v163, v163
    v_exp_f32 v164, v164
    v_exp_f32 v165, v165
    v_exp_f32 v166, v166
    v_exp_f32 v167, v167
    v_pk_add_f32 v[136:137], v[152:153], v[154:155]
    s_lshl_b32 s66, s6, 12
    buffer_load_dwordx4 a[40:43], v3, s[44:47], s66 offen offset:2048 sc0 sc1
    v_pk_add_f32 v[138:139], v[156:157], v[158:159]
    v_pk_add_f32 v[140:141], v[160:161], v[162:163]
    v_pk_add_f32 v[142:143], v[164:165], v[166:167]
    v_pk_add_f32 v[136:137], v[136:137], v[138:139]
    v_pk_add_f32 v[140:141], v[140:141], v[142:143]
    v_add_f32 v168, v136, v137
    v_add_f32 v169, v140, v141
    v_mov_b32 v170, 0
    s_nop 0
    v_permlane32_swap_b32 v168, v169
    v_add_f32 v168, v168, v169
    s_lshl_b32 s66, s6, 12
    buffer_load_dwordx4 a[44:47], v3, s[44:47], s66 offen offset:3072 sc0 sc1
    v_rcp_f32 v168, v168
    s_nop 0
    v_mov_b32 v169, v168
    v_mov_b32 v170, 0
    s_nop 0
    v_permlane32_swap_b32 v168, v169
    v_mov_b32 v170, v169
    v_pk_mul_f32 v[152:153], v[152:153], v[168:169] op_sel_hi:[1,0]
    v_pk_mul_f32 v[154:155], v[154:155], v[168:169] op_sel_hi:[1,0]
    v_pk_mul_f32 v[156:157], v[156:157], v[168:169] op_sel_hi:[1,0]
    v_pk_mul_f32 v[158:159], v[158:159], v[168:169] op_sel_hi:[1,0]
    v_pk_mul_f32 v[160:161], v[160:161], v[170:171] op_sel_hi:[1,0]
    s_lshl_b32 s66, s7, 12
    buffer_load_dwordx4 a[48:51], v3, s[44:47], s66 offen sc0 sc1
    v_pk_mul_f32 v[162:163], v[162:163], v[170:171] op_sel_hi:[1,0]
    v_pk_mul_f32 v[164:165], v[164:165], v[170:171] op_sel_hi:[1,0]
    v_pk_mul_f32 v[166:167], v[166:167], v[170:171] op_sel_hi:[1,0]
    v_cvt_pk_bf16_f32 v172, v152, v153
    v_cvt_pk_bf16_f32 v173, v154, v155
    v_cvt_pk_bf16_f32 v174, v156, v157
    v_cvt_pk_bf16_f32 v175, v158, v159
    v_cvt_pk_bf16_f32 v176, v160, v161
    v_cvt_pk_bf16_f32 v177, v162, v163
    v_cvt_pk_bf16_f32 v178, v164, v165
    s_lshl_b32 s66, s7, 12
    buffer_load_dwordx4 a[52:55], v3, s[44:47], s66 offen offset:1024 sc0 sc1
    v_cvt_pk_bf16_f32 v179, v166, v167
    v_mfma_f32_32x32x16_bf16 v[136:151], v[20:23], v[132:135], 0
    v_mov_b32 v170, 0
    v_mov_b32 v170, 0
    v_mov_b32 v170, 0
    v_mov_b32 v170, 0
    v_mov_b32 v170, 0
    v_mov_b32 v170, 0
    v_mov_b32 v170, 0
    v_mov_b32 v170, 0
    s_lshl_b32 s66, s7, 12
    buffer_load_dwordx4 a[56:59], v3, s[44:47], s66 offen offset:2048 sc0 sc1
    s_nop 1
    v_cvt_pk_bf16_f32 v152, v136, v137
    v_cvt_pk_bf16_f32 v153, v138, v139
    v_cvt_pk_bf16_f32 v154, v140, v141
    v_cvt_pk_bf16_f32 v155, v142, v143
    v_lshlrev_b32 v136, 16, v152
    v_and_b32 v137, 0xffff0000, v152
    v_lshlrev_b32 v138, 16, v153
    v_and_b32 v139, 0xffff0000, v153
    v_lshlrev_b32 v140, 16, v154
    v_and_b32 v141, 0xffff0000, v154
    s_lshl_b32 s66, s7, 12
    buffer_load_dwordx4 a[60:63], v3, s[44:47], s66 offen offset:3072 sc0 sc1
    s_mov_b32 s36, s20
    s_and_b32 s37, s21, 65535
    s_mov_b32 s38, 0x400
    s_mov_b32 s39, 0x00020000
    s_mov_b32 s40, s22
    s_and_b32 s41, s23, 65535
    s_mov_b32 s42, 0x200000
    s_mov_b32 s43, 0x00020000
    s_waitcnt vmcnt(53) lgkmcnt(0)
    ds_read_b64_tr_b16 v[96:97], v14 offset:32768
    ds_read_b64_tr_b16 v[98:99], v14 offset:33792
    ds_read_b64_tr_b16 v[100:101], v15 offset:32768
    ds_read_b64_tr_b16 v[102:103], v15 offset:33792
    ds_read_b64_tr_b16 v[104:105], v14 offset:34816
    ds_read_b64_tr_b16 v[106:107], v14 offset:35840
    ds_read_b64_tr_b16 v[108:109], v15 offset:34816
    ds_read_b64_tr_b16 v[110:111], v15 offset:35840
    s_lshl_b32 s66, s8, 12
    buffer_load_dwordx4 a[64:67], v3, s[44:47], s66 offen sc0 sc1
    s_lshl_b32 s66, s8, 12
    buffer_load_dwordx4 a[68:71], v3, s[44:47], s66 offen offset:1024 sc0 sc1
    s_lshl_b32 s66, s8, 12
    buffer_load_dwordx4 a[72:75], v3, s[44:47], s66 offen offset:2048 sc0 sc1
    s_lshl_b32 s66, s8, 12
    buffer_load_dwordx4 a[76:79], v3, s[44:47], s66 offen offset:3072 sc0 sc1
    s_lshl_b32 s66, s9, 12
    buffer_load_dwordx4 a[80:83], v3, s[44:47], s66 offen sc0 sc1
    s_lshl_b32 s66, s9, 12
    buffer_load_dwordx4 a[84:87], v3, s[44:47], s66 offen offset:1024 sc0 sc1
    s_lshl_b32 s66, s9, 12
    buffer_load_dwordx4 a[88:91], v3, s[44:47], s66 offen offset:2048 sc0 sc1
    s_lshl_b32 s66, s9, 12
    buffer_load_dwordx4 a[92:95], v3, s[44:47], s66 offen offset:3072 sc0 sc1
    s_waitcnt vmcnt(61) lgkmcnt(0)
    ds_read_b64_tr_b16 v[112:113], v14 offset:36864
    ds_read_b64_tr_b16 v[114:115], v14 offset:37888
    ds_read_b64_tr_b16 v[116:117], v15 offset:36864
    ds_read_b64_tr_b16 v[118:119], v15 offset:37888
    s_waitcnt vmcnt(27)
    v_mfma_f32_32x32x16_bf16 v[32:47], v[96:99], a[0:3], 0
    ds_read_b64_tr_b16 v[120:121], v14 offset:38912
    ds_read_b64_tr_b16 v[122:123], v14 offset:39936
    ds_read_b64_tr_b16 v[124:125], v15 offset:38912
    v_lshlrev_b32 v142, 16, v155
    v_and_b32 v143, 0xffff0000, v155
    v_max3_f32 v168, v136, v137, v138
    v_max3_f32 v152, v139, v140, v141
    v_max3_f32 v169, -v136, -v137, -v138
    v_max3_f32 v153, -v139, -v140, -v141
    v_max3_f32 v168, v168, v142, v143
    v_max3_f32 v169, v169, -v142, -v143
    v_max_f32 v168, v168, v152
    v_max_f32 v169, v169, v153
    v_mov_b32 v170, 0
    s_nop 0
    v_permlane32_swap_b32 v168, v169
    v_mfma_f32_32x32x16_bf16 v[48:63], v[96:99], a[8:11], 0
    ds_read_b64_tr_b16 v[126:127], v15 offset:39936
    v_max_f32 v168, v168, v169
    v_mul_f32 v168, 0x3fb8aa3b, v168
    v_mov_b32 v169, v168
    v_mov_b32 v170, 0
    s_nop 0
    v_permlane32_swap_b32 v168, v169
    v_fma_f32 v152, v136, v10, -v168
    v_fma_f32 v153, v137, v10, -v168
    v_fma_f32 v154, v138, v10, -v168
    v_fma_f32 v155, v139, v10, -v168
    v_fma_f32 v156, v140, v10, -v168
    v_fma_f32 v157, v141, v10, -v168
    v_fma_f32 v158, v142, v10, -v168
    v_mfma_f32_32x32x16_bf16 v[64:79], v[100:103], a[0:3], 0
    v_fma_f32 v159, v143, v10, -v168
    v_fma_f32 v160, -v136, v10, -v169
    v_fma_f32 v161, -v137, v10, -v169
    v_fma_f32 v162, -v138, v10, -v169
    v_fma_f32 v163, -v139, v10, -v169
    v_fma_f32 v164, -v140, v10, -v169
    v_fma_f32 v165, -v141, v10, -v169
    v_fma_f32 v166, -v142, v10, -v169
    v_fma_f32 v167, -v143, v10, -v169
    v_exp_f32 v152, v152
    v_exp_f32 v153, v153
    v_exp_f32 v154, v154
    v_mfma_f32_32x32x16_bf16 v[80:95], v[100:103], a[8:11], 0
    v_exp_f32 v155, v155
    v_exp_f32 v156, v156
    v_exp_f32 v157, v157
    v_exp_f32 v158, v158
    v_exp_f32 v159, v159
    v_exp_f32 v160, v160
    v_exp_f32 v161, v161
    v_exp_f32 v162, v162
    v_exp_f32 v163, v163
    v_exp_f32 v164, v164
    v_exp_f32 v165, v165
    v_exp_f32 v166, v166
    v_mfma_f32_32x32x16_bf16 v[32:47], v[104:107], a[4:7], v[32:47]
    v_exp_f32 v167, v167
    v_pk_add_f32 v[136:137], v[152:153], v[154:155]
    v_pk_add_f32 v[138:139], v[156:157], v[158:159]
    v_pk_add_f32 v[140:141], v[160:161], v[162:163]
    v_pk_add_f32 v[142:143], v[164:165], v[166:167]
    v_pk_add_f32 v[136:137], v[136:137], v[138:139]
    v_pk_add_f32 v[140:141], v[140:141], v[142:143]
    v_add_f32 v168, v136, v137
    v_add_f32 v169, v140, v141
    v_mov_b32 v170, 0
    s_nop 0
    v_permlane32_swap_b32 v168, v169
    v_add_f32 v168, v168, v169
    v_mfma_f32_32x32x16_bf16 v[48:63], v[104:107], a[12:15], v[48:63]
    v_rcp_f32 v168, v168
    s_nop 0
    v_mov_b32 v169, v168
    v_mov_b32 v170, 0
    s_nop 0
    v_permlane32_swap_b32 v168, v169
    v_mov_b32 v170, v169
    v_pk_mul_f32 v[152:153], v[152:153], v[168:169] op_sel_hi:[1,0]
    v_pk_mul_f32 v[154:155], v[154:155], v[168:169] op_sel_hi:[1,0]
    v_pk_mul_f32 v[156:157], v[156:157], v[168:169] op_sel_hi:[1,0]
    v_pk_mul_f32 v[158:159], v[158:159], v[168:169] op_sel_hi:[1,0]
    v_pk_mul_f32 v[160:161], v[160:161], v[170:171] op_sel_hi:[1,0]
    v_pk_mul_f32 v[162:163], v[162:163], v[170:171] op_sel_hi:[1,0]
    v_pk_mul_f32 v[164:165], v[164:165], v[170:171] op_sel_hi:[1,0]
    v_mfma_f32_32x32x16_bf16 v[64:79], v[108:111], a[4:7], v[64:79]
    v_pk_mul_f32 v[166:167], v[166:167], v[170:171] op_sel_hi:[1,0]
    v_cvt_pk_bf16_f32 v180, v152, v153
    v_cvt_pk_bf16_f32 v181, v154, v155
    v_cvt_pk_bf16_f32 v182, v156, v157
    v_cvt_pk_bf16_f32 v183, v158, v159
    v_cvt_pk_bf16_f32 v184, v160, v161
    v_cvt_pk_bf16_f32 v185, v162, v163
    v_cvt_pk_bf16_f32 v186, v164, v165
    v_cvt_pk_bf16_f32 v187, v166, v167
    s_waitcnt vmcnt(20)
    s_mov_b32 s86, 0
L_kvd_chk:
    v_xor_b32 v9, s64, v191
    v_xor_b32 v10, s64, v195
    v_or_b32 v9, v9, v10
    v_xor_b32 v10, s64, v199
    v_or_b32 v9, v9, v10
    v_xor_b32 v10, s64, v203
    v_or_b32 v9, v9, v10
    v_xor_b32 v10, s64, v207
    v_or_b32 v9, v9, v10
    v_xor_b32 v10, s64, v211
    v_or_b32 v9, v9, v10
    v_cmp_ne_u32 vcc, 0, v9
    s_nop 0
    s_cmp_eq_u64 vcc, 0
    s_cbranch_scc1 L_kvd_ok
    s_add_u32 s86, s86, 1
    s_cmp_ge_u32 s86, 200000
    s_cbranch_scc1 L_kvd_ok
    s_sleep 2
    s_lshl_b32 s0, s57, 2
    s_lshl_b32 s1, s61, 1
    s_add_u32 s0, s0, s1
    s_mul_i32 s0, s0, 3072
    s_add_u32 s0, s0, 0x1800000
    s_add_u32 s1, s0, 3072
    buffer_load_dwordx4 v[188:191], v24, s[44:47], s0 offen sc0 sc1
    buffer_load_dwordx4 v[192:195], v24, s[44:47], s0 offen offset:1024 sc0 sc1
    buffer_load_dwordx4 v[196:199], v24, s[44:47], s0 offen offset:2048 sc0 sc1
    buffer_load_dwordx4 v[200:203], v24, s[44:47], s1 offen sc0 sc1
    buffer_load_dwordx4 v[204:207], v24, s[44:47], s1 offen offset:1024 sc0 sc1
    buffer_load_dwordx4 v[208:211], v24, s[44:47], s1 offen offset:2048 sc0 sc1
    s_waitcnt vmcnt(0)
    s_branch L_kvd_chk
L_kvd_ok:
    v_mov_b32 v212, v188
    v_mov_b32 v213, v189
    v_mfma_f32_32x32x16_bf16 v[80:95], v[108:111], a[12:15], v[80:95]
    v_mov_b32 v214, v190
    v_mov_b32 v215, v192
    v_mov_b32 v216, v193
    v_mov_b32 v217, v194
    v_mov_b32 v218, v196
    v_mov_b32 v219, v197
    v_mov_b32 v220, v200
    v_mov_b32 v221, v201
    v_mov_b32 v222, v202
    v_mov_b32 v223, v204
    v_mov_b32 v224, v205
    v_mov_b32 v225, v206
    s_waitcnt vmcnt(52) lgkmcnt(0)
    ds_read_b64_tr_b16 v[96:97], v12
    ds_read_b64_tr_b16 v[98:99], v12 offset:1024
    ds_read_b64_tr_b16 v[100:101], v13
    ds_read_b64_tr_b16 v[102:103], v13 offset:1024
    s_waitcnt vmcnt(16)
    v_mfma_f32_32x32x16_bf16 v[32:47], v[112:115], a[16:19], v[32:47]
    ds_read_b64_tr_b16 v[104:105], v12 offset:2048
    ds_read_b64_tr_b16 v[106:107], v12 offset:3072
    ds_read_b64_tr_b16 v[108:109], v13 offset:2048
    v_mov_b32 v226, v208
    v_mov_b32 v227, v209
    s_mul_i32 s0, s56, 72
    s_lshl_b32 s1, s57, 1
    s_add_u32 s0, s0, s1
    s_add_u32 s0, s0, s61
    s_add_u32 s0, s0, 56
    s_lshl_b32 s0, s0, 12
    s_lshl_b32 s1, s62, 11
    s_add_u32 s0, s0, s1
    v_mfma_f32_32x32x16_bf16 v[136:151], v[212:215], v[172:175], 0
    v_mfma_f32_32x32x16_bf16 v[136:151], v[216:219], v[176:179], v[136:151]
    v_mfma_f32_32x32x16_bf16 v[48:63], v[112:115], a[24:27], v[48:63]
    ds_read_b64_tr_b16 v[110:111], v13 offset:3072
    s_lshl_b32 s66, s60, 3
    s_add_u32 m0, s66, 0x18000
    s_lshl_b32 s65, s12, 15
    buffer_load_dwordx4 v2, s[48:51], s65 offen lds
    s_lshl_b32 s66, s60, 3
    s_add_u32 m0, s66, 0x18400
    s_lshl_b32 s65, s12, 15
    s_add_u32 s65, s65, 8192
    buffer_load_dwordx4 v2, s[48:51], s65 offen lds
    v_mfma_f32_32x32x16_bf16 v[152:167], v[220:223], v[180:183], 0
    v_mfma_f32_32x32x16_bf16 v[152:167], v[224:227], v[184:187], v[152:167]
    v_cvt_pk_bf16_f32 v128, v136, v137
    v_cvt_pk_bf16_f32 v129, v138, v139
    v_cvt_pk_bf16_f32 v130, v140, v141
    v_cvt_pk_bf16_f32 v131, v142, v143
    v_lshlrev_b32 v136, 16, v128
    v_and_b32 v137, 0xffff0000, v128
    v_lshlrev_b32 v138, 16, v129
    v_and_b32 v139, 0xffff0000, v129
    v_lshlrev_b32 v140, 16, v130
    v_and_b32 v141, 0xffff0000, v130
    v_mfma_f32_32x32x16_bf16 v[64:79], v[116:119], a[16:19], v[64:79]
    s_lshl_b32 s66, s60, 3
    s_add_u32 m0, s66, 0x18800
    s_lshl_b32 s65, s12, 15
    s_add_u32 s65, s65, 16384
    buffer_load_dwordx4 v2, s[48:51], s65 offen lds
    s_lshl_b32 s66, s60, 3
    s_add_u32 m0, s66, 0x18c00
    s_lshl_b32 s65, s12, 15
    s_add_u32 s65, s65, 24576
    buffer_load_dwordx4 v2, s[48:51], s65 offen lds
    s_lshl_b32 s66, s60, 3
    s_add_u32 m0, s66, 0x19000
    s_lshl_b32 s65, s13, 15
    buffer_load_dwordx4 v2, s[48:51], s65 offen lds
    v_lshlrev_b32 v142, 16, v131
    v_and_b32 v143, 0xffff0000, v131
    v_cvt_pk_bf16_f32 v144, v144, v144
    v_lshlrev_b32 v144, 16, v144
    v_add_f32 v144, 0x358637bd, v144
    v_cvt_pk_bf16_f32 v144, v144, v144
    v_lshlrev_b32 v144, 16, v144
    v_rcp_f32 v146, v144
    s_nop 0
    v_fma_f32 v145, -v144, v146, 1.0
    v_fma_f32 v146, v145, v146, v146
    v_pk_mul_f32 v[136:137], v[136:137], v[146:147] op_sel_hi:[1,0]
    v_pk_mul_f32 v[138:139], v[138:139], v[146:147] op_sel_hi:[1,0]
    v_mfma_f32_32x32x16_bf16 v[80:95], v[116:119], a[24:27], v[80:95]
    s_lshl_b32 s66, s60, 3
    s_add_u32 m0, s66, 0x19400
    s_lshl_b32 s65, s13, 15
    s_add_u32 s65, s65, 8192
    buffer_load_dwordx4 v2, s[48:51], s65 offen lds
    s_lshl_b32 s66, s60, 3
    s_add_u32 m0, s66, 0x19800
    s_lshl_b32 s65, s13, 15
    s_add_u32 s65, s65, 16384
    buffer_load_dwordx4 v2, s[48:51], s65 offen lds
    s_lshl_b32 s66, s60, 3
    s_add_u32 m0, s66, 0x19c00
    s_lshl_b32 s65, s13, 15
    s_add_u32 s65, s65, 24576
    buffer_load_dwordx4 v2, s[48:51], s65 offen lds
    v_pk_mul_f32 v[140:141], v[140:141], v[146:147] op_sel_hi:[1,0]
    v_pk_mul_f32 v[142:143], v[142:143], v[146:147] op_sel_hi:[1,0]
    v_cvt_pk_bf16_f32 v148, v136, v137
    v_cvt_pk_bf16_f32 v149, v138, v139
    v_cvt_pk_bf16_f32 v150, v140, v141
    v_cvt_pk_bf16_f32 v151, v142, v143
    buffer_store_dwordx4 v[148:151], v5, s[44:47], s0 offen sc0 sc1
    v_cvt_pk_bf16_f32 v128, v152, v153
    v_cvt_pk_bf16_f32 v129, v154, v155
    v_cvt_pk_bf16_f32 v130, v156, v157
    v_cvt_pk_bf16_f32 v131, v158, v159
    v_lshlrev_b32 v152, 16, v128
    v_mfma_f32_32x32x16_bf16 v[32:47], v[120:123], a[20:23], v[32:47]
    v_and_b32 v153, 0xffff0000, v128
    v_lshlrev_b32 v154, 16, v129
    v_and_b32 v155, 0xffff0000, v129
    v_lshlrev_b32 v156, 16, v130
    v_and_b32 v157, 0xffff0000, v130
    v_lshlrev_b32 v158, 16, v131
    v_and_b32 v159, 0xffff0000, v131
    v_cvt_pk_bf16_f32 v160, v160, v160
    v_lshlrev_b32 v160, 16, v160
    v_add_f32 v160, 0x358637bd, v160
    v_cvt_pk_bf16_f32 v160, v160, v160
    v_lshlrev_b32 v160, 16, v160
    v_mfma_f32_32x32x16_bf16 v[48:63], v[120:123], a[28:31], v[48:63]
    v_rcp_f32 v162, v160
    s_nop 0
    v_fma_f32 v161, -v160, v162, 1.0
    v_fma_f32 v162, v161, v162, v162
    v_pk_mul_f32 v[152:153], v[152:153], v[162:163] op_sel_hi:[1,0]
    v_pk_mul_f32 v[154:155], v[154:155], v[162:163] op_sel_hi:[1,0]
    v_pk_mul_f32 v[156:157], v[156:157], v[162:163] op_sel_hi:[1,0]
    v_pk_mul_f32 v[158:159], v[158:159], v[162:163] op_sel_hi:[1,0]
    v_cvt_pk_bf16_f32 v164, v152, v153
    v_cvt_pk_bf16_f32 v165, v154, v155
    v_cvt_pk_bf16_f32 v166, v156, v157
    v_cvt_pk_bf16_f32 v167, v158, v159
    buffer_store_dwordx4 v[164:167], v5, s[44:47], s0 offen offset:1024 sc0 sc1
    v_mfma_f32_32x32x16_bf16 v[64:79], v[124:127], a[20:23], v[64:79]
    v_mfma_f32_32x32x16_bf16 v[80:95], v[124:127], a[28:31], v[80:95]
    s_waitcnt vmcnt(62) lgkmcnt(0)
    ds_read_b64_tr_b16 v[112:113], v12 offset:4096
    ds_read_b64_tr_b16 v[114:115], v12 offset:5120
    ds_read_b64_tr_b16 v[116:117], v13 offset:4096
    ds_read_b64_tr_b16 v[118:119], v13 offset:5120
    s_waitcnt vmcnt(22)
    v_mfma_f32_32x32x16_bf16 v[32:47], v[96:99], a[32:35], v[32:47]
    ds_read_b64_tr_b16 v[120:121], v12 offset:6144
    ds_read_b64_tr_b16 v[122:123], v12 offset:7168
    ds_read_b64_tr_b16 v[124:125], v13 offset:6144
    v_mfma_f32_32x32x16_bf16 v[48:63], v[96:99], a[40:43], v[48:63]
    ds_read_b64_tr_b16 v[126:127], v13 offset:7168
    v_mfma_f32_32x32x16_bf16 v[64:79], v[100:103], a[32:35], v[64:79]
    v_mfma_f32_32x32x16_bf16 v[80:95], v[100:103], a[40:43], v[80:95]
    v_mfma_f32_32x32x16_bf16 v[32:47], v[104:107], a[36:39], v[32:47]
    v_mfma_f32_32x32x16_bf16 v[48:63], v[104:107], a[44:47], v[48:63]
    v_mfma_f32_32x32x16_bf16 v[64:79], v[108:111], a[36:39], v[64:79]
    v_mfma_f32_32x32x16_bf16 v[80:95], v[108:111], a[44:47], v[80:95]
    s_waitcnt vmcnt(49) lgkmcnt(0)
    s_lshl_b32 s65, s56, 7
    s_lshl_b32 s66, s58, 5
    s_add_u32 s65, s65, s66
    s_add_u32 s65, s65, 0x1a08000
    buffer_load_dword v25, v6, s[44:47], s65 offen sc0 sc1
    ds_read_b64_tr_b16 v[96:97], v12 offset:32768
    ds_read_b64_tr_b16 v[98:99], v12 offset:33792
    ds_read_b64_tr_b16 v[100:101], v13 offset:32768
    ds_read_b64_tr_b16 v[102:103], v13 offset:33792
    s_waitcnt vmcnt(19)
    v_mfma_f32_32x32x16_bf16 v[32:47], v[112:115], a[48:51], v[32:47]
    ds_read_b64_tr_b16 v[104:105], v12 offset:34816
    ds_read_b64_tr_b16 v[106:107], v12 offset:35840
    ds_read_b64_tr_b16 v[108:109], v13 offset:34816
    v_mfma_f32_32x32x16_bf16 v[48:63], v[112:115], a[56:59], v[48:63]
    ds_read_b64_tr_b16 v[110:111], v13 offset:35840
    s_lshl_b32 s66, s60, 3
    s_add_u32 m0, s66, 0x0
    s_lshl_b32 s65, s14, 15
    buffer_load_dwordx4 v2, s[48:51], s65 offen lds
    s_lshl_b32 s66, s60, 3
    s_add_u32 m0, s66, 0x400
    s_lshl_b32 s65, s14, 15
    s_add_u32 s65, s65, 8192
    buffer_load_dwordx4 v2, s[48:51], s65 offen lds
    v_mfma_f32_32x32x16_bf16 v[64:79], v[116:119], a[48:51], v[64:79]
    s_lshl_b32 s66, s60, 3
    s_add_u32 m0, s66, 0x800
    s_lshl_b32 s65, s14, 15
    s_add_u32 s65, s65, 16384
    buffer_load_dwordx4 v2, s[48:51], s65 offen lds
    s_lshl_b32 s66, s60, 3
    s_add_u32 m0, s66, 0xc00
    s_lshl_b32 s65, s14, 15
    s_add_u32 s65, s65, 24576
    buffer_load_dwordx4 v2, s[48:51], s65 offen lds
    s_lshl_b32 s66, s60, 3
    s_add_u32 m0, s66, 0x1000
    s_lshl_b32 s65, s15, 15
    buffer_load_dwordx4 v2, s[48:51], s65 offen lds
    v_mfma_f32_32x32x16_bf16 v[80:95], v[116:119], a[56:59], v[80:95]
    s_lshl_b32 s66, s60, 3
    s_add_u32 m0, s66, 0x1400
    s_lshl_b32 s65, s15, 15
    s_add_u32 s65, s65, 8192
    buffer_load_dwordx4 v2, s[48:51], s65 offen lds
    s_lshl_b32 s66, s60, 3
    s_add_u32 m0, s66, 0x1800
    s_lshl_b32 s65, s15, 15
    s_add_u32 s65, s65, 16384
    buffer_load_dwordx4 v2, s[48:51], s65 offen lds
    s_lshl_b32 s66, s60, 3
    s_add_u32 m0, s66, 0x1c00
    s_lshl_b32 s65, s15, 15
    s_add_u32 s65, s65, 24576
    buffer_load_dwordx4 v2, s[48:51], s65 offen lds
    v_mfma_f32_32x32x16_bf16 v[32:47], v[120:123], a[52:55], v[32:47]
    v_mfma_f32_32x32x16_bf16 v[48:63], v[120:123], a[60:63], v[48:63]
    v_mfma_f32_32x32x16_bf16 v[64:79], v[124:127], a[52:55], v[64:79]
    v_mfma_f32_32x32x16_bf16 v[80:95], v[124:127], a[60:63], v[80:95]
    s_waitcnt vmcnt(58) lgkmcnt(0)
    s_waitcnt vmcnt(8)
    s_lshl_b32 s65, s56, 7
    s_lshl_b32 s66, s57, 4
    s_add_u32 s65, s65, s66
    s_lshl_b32 s66, s58, 2
    s_add_u32 s65, s65, s66
    s_add_u32 s65, s65, 0x1a0c000
    v_mov_b32 v29, 0
    v_mov_b32 v30, s64
    s_mov_b64 exec, 1
    buffer_store_dword v30, v29, s[44:47], s65 offen sc0 sc1
    s_mov_b64 exec, -1
    s_setprio 0
    s_mov_b32 s86, 0
L_hb_chk:
    v_xor_b32 v29, s64, v25
    v_cmp_ne_u32 vcc, 0, v29
    s_nop 0
    s_cmp_eq_u64 vcc, 0
    s_cbranch_scc1 L_hb_ok
    s_add_u32 s86, s86, 1
    s_cmp_ge_u32 s86, 200000
    s_cbranch_scc1 L_hb_ok
    s_sleep 2
    s_lshl_b32 s65, s56, 7
    s_lshl_b32 s66, s58, 5
    s_add_u32 s65, s65, s66
    s_add_u32 s65, s65, 0x1a08000
    buffer_load_dword v25, v6, s[44:47], s65 offen sc0 sc1
    s_waitcnt vmcnt(0)
    s_branch L_hb_chk
L_hb_ok:
    s_lshl_b32 s66, s10, 12
    buffer_load_dwordx4 a[96:99], v3, s[44:47], s66 offen sc0 sc1
    s_lshl_b32 s66, s10, 12
    buffer_load_dwordx4 a[100:103], v3, s[44:47], s66 offen offset:1024 sc0 sc1
    s_lshl_b32 s66, s10, 12
    buffer_load_dwordx4 a[104:107], v3, s[44:47], s66 offen offset:2048 sc0 sc1
    s_lshl_b32 s66, s10, 12
    buffer_load_dwordx4 a[108:111], v3, s[44:47], s66 offen offset:3072 sc0 sc1
    s_lshl_b32 s66, s11, 12
    buffer_load_dwordx4 a[112:115], v3, s[44:47], s66 offen sc0 sc1
    s_lshl_b32 s66, s11, 12
    buffer_load_dwordx4 a[116:119], v3, s[44:47], s66 offen offset:1024 sc0 sc1
    s_lshl_b32 s66, s11, 12
    buffer_load_dwordx4 a[120:123], v3, s[44:47], s66 offen offset:2048 sc0 sc1
    s_lshl_b32 s66, s11, 12
    buffer_load_dwordx4 a[124:127], v3, s[44:47], s66 offen offset:3072 sc0 sc1
    ds_read_b64_tr_b16 v[112:113], v12 offset:36864
    ds_read_b64_tr_b16 v[114:115], v12 offset:37888
    ds_read_b64_tr_b16 v[116:117], v13 offset:36864
    ds_read_b64_tr_b16 v[118:119], v13 offset:37888
    s_waitcnt vmcnt(32)
    v_mfma_f32_32x32x16_bf16 v[32:47], v[96:99], a[64:67], v[32:47]
    ds_read_b64_tr_b16 v[120:121], v12 offset:38912
    ds_read_b64_tr_b16 v[122:123], v12 offset:39936
    ds_read_b64_tr_b16 v[124:125], v13 offset:38912
    v_mfma_f32_32x32x16_bf16 v[48:63], v[96:99], a[72:75], v[48:63]
    ds_read_b64_tr_b16 v[126:127], v13 offset:39936
    s_lshl_b32 s66, s12, 12
    buffer_load_dwordx4 a[128:131], v3, s[44:47], s66 offen sc0 sc1
    s_lshl_b32 s66, s12, 12
    buffer_load_dwordx4 a[132:135], v3, s[44:47], s66 offen offset:1024 sc0 sc1
    v_mfma_f32_32x32x16_bf16 v[64:79], v[100:103], a[64:67], v[64:79]
    s_lshl_b32 s66, s12, 12
    buffer_load_dwordx4 a[136:139], v3, s[44:47], s66 offen offset:2048 sc0 sc1
    s_lshl_b32 s66, s12, 12
    buffer_load_dwordx4 a[140:143], v3, s[44:47], s66 offen offset:3072 sc0 sc1
    s_lshl_b32 s66, s13, 12
    buffer_load_dwordx4 a[144:147], v3, s[44:47], s66 offen sc0 sc1
    v_mfma_f32_32x32x16_bf16 v[80:95], v[100:103], a[72:75], v[80:95]
    s_lshl_b32 s66, s13, 12
    buffer_load_dwordx4 a[148:151], v3, s[44:47], s66 offen offset:1024 sc0 sc1
    s_lshl_b32 s66, s13, 12
    buffer_load_dwordx4 a[152:155], v3, s[44:47], s66 offen offset:2048 sc0 sc1
    s_lshl_b32 s66, s13, 12
    buffer_load_dwordx4 a[156:159], v3, s[44:47], s66 offen offset:3072 sc0 sc1
    v_mfma_f32_32x32x16_bf16 v[32:47], v[104:107], a[68:71], v[32:47]
    v_mfma_f32_32x32x16_bf16 v[48:63], v[104:107], a[76:79], v[48:63]
    v_mfma_f32_32x32x16_bf16 v[64:79], v[108:111], a[68:71], v[64:79]
    v_mfma_f32_32x32x16_bf16 v[80:95], v[108:111], a[76:79], v[80:95]
    s_waitcnt vmcnt(63) lgkmcnt(0)
    ds_read_b64_tr_b16 v[96:97], v14
    ds_read_b64_tr_b16 v[98:99], v14 offset:1024
    ds_read_b64_tr_b16 v[100:101], v15
    ds_read_b64_tr_b16 v[102:103], v15 offset:1024
    s_waitcnt vmcnt(36)
    v_mfma_f32_32x32x16_bf16 v[32:47], v[112:115], a[80:83], v[32:47]
    ds_read_b64_tr_b16 v[104:105], v14 offset:2048
    ds_read_b64_tr_b16 v[106:107], v14 offset:3072
    ds_read_b64_tr_b16 v[108:109], v15 offset:2048
    v_mfma_f32_32x32x16_bf16 v[48:63], v[112:115], a[88:91], v[48:63]
    ds_read_b64_tr_b16 v[110:111], v15 offset:3072
    s_lshl_b32 s66, s14, 12
    buffer_load_dwordx4 a[160:163], v3, s[44:47], s66 offen sc0 sc1
    s_lshl_b32 s66, s14, 12
    buffer_load_dwordx4 a[164:167], v3, s[44:47], s66 offen offset:1024 sc0 sc1
    v_mfma_f32_32x32x16_bf16 v[64:79], v[116:119], a[80:83], v[64:79]
    s_lshl_b32 s66, s14, 12
    buffer_load_dwordx4 a[168:171], v3, s[44:47], s66 offen offset:2048 sc0 sc1
    s_lshl_b32 s66, s14, 12
    buffer_load_dwordx4 a[172:175], v3, s[44:47], s66 offen offset:3072 sc0 sc1
    s_lshl_b32 s66, s15, 12
    buffer_load_dwordx4 a[176:179], v3, s[44:47], s66 offen sc0 sc1
    v_mfma_f32_32x32x16_bf16 v[80:95], v[116:119], a[88:91], v[80:95]
    s_lshl_b32 s66, s15, 12
    buffer_load_dwordx4 a[180:183], v3, s[44:47], s66 offen offset:1024 sc0 sc1
    s_lshl_b32 s66, s15, 12
    buffer_load_dwordx4 a[184:187], v3, s[44:47], s66 offen offset:2048 sc0 sc1
    s_lshl_b32 s66, s15, 12
    buffer_load_dwordx4 a[188:191], v3, s[44:47], s66 offen offset:3072 sc0 sc1
    v_mfma_f32_32x32x16_bf16 v[32:47], v[120:123], a[84:87], v[32:47]
    s_lshl_b32 s66, s60, 3
    s_add_u32 m0, s66, 0x8000
    s_lshl_b32 s65, s16, 15
    buffer_load_dwordx4 v2, s[48:51], s65 offen lds
    s_lshl_b32 s66, s60, 3
    s_add_u32 m0, s66, 0x8400
    s_lshl_b32 s65, s16, 15
    s_add_u32 s65, s65, 8192
    buffer_load_dwordx4 v2, s[48:51], s65 offen lds
    s_lshl_b32 s66, s60, 3
    s_add_u32 m0, s66, 0x8800
    s_lshl_b32 s65, s16, 15
    s_add_u32 s65, s65, 16384
    buffer_load_dwordx4 v2, s[48:51], s65 offen lds
    v_mfma_f32_32x32x16_bf16 v[48:63], v[120:123], a[92:95], v[48:63]
    s_lshl_b32 s66, s60, 3
    s_add_u32 m0, s66, 0x8c00
    s_lshl_b32 s65, s16, 15
    s_add_u32 s65, s65, 24576
    buffer_load_dwordx4 v2, s[48:51], s65 offen lds
    s_lshl_b32 s66, s60, 3
    s_add_u32 m0, s66, 0x9000
    s_lshl_b32 s65, s17, 15
    buffer_load_dwordx4 v2, s[48:51], s65 offen lds
    s_lshl_b32 s66, s60, 3
    s_add_u32 m0, s66, 0x9400
    s_lshl_b32 s65, s17, 15
    s_add_u32 s65, s65, 8192
    buffer_load_dwordx4 v2, s[48:51], s65 offen lds
    v_mfma_f32_32x32x16_bf16 v[64:79], v[124:127], a[84:87], v[64:79]
    s_lshl_b32 s66, s60, 3
    s_add_u32 m0, s66, 0x9800
    s_lshl_b32 s65, s17, 15
    s_add_u32 s65, s65, 16384
    buffer_load_dwordx4 v2, s[48:51], s65 offen lds
    s_lshl_b32 s66, s60, 3
    s_add_u32 m0, s66, 0x9c00
    s_lshl_b32 s65, s17, 15
    s_add_u32 s65, s65, 24576
    buffer_load_dwordx4 v2, s[48:51], s65 offen lds
    v_mfma_f32_32x32x16_bf16 v[80:95], v[124:127], a[92:95], v[80:95]
    s_waitcnt vmcnt(63) lgkmcnt(0)
    ds_read_b64_tr_b16 v[112:113], v14 offset:4096
    ds_read_b64_tr_b16 v[114:115], v14 offset:5120
    ds_read_b64_tr_b16 v[116:117], v15 offset:4096
    ds_read_b64_tr_b16 v[118:119], v15 offset:5120
    s_waitcnt vmcnt(28)
    v_mfma_f32_32x32x16_bf16 v[32:47], v[96:99], a[96:99], v[32:47]
    ds_read_b64_tr_b16 v[120:121], v14 offset:6144
    ds_read_b64_tr_b16 v[122:123], v14 offset:7168
    ds_read_b64_tr_b16 v[124:125], v15 offset:6144
    v_mfma_f32_32x32x16_bf16 v[48:63], v[96:99], a[104:107], v[48:63]
    ds_read_b64_tr_b16 v[126:127], v15 offset:7168
    s_lshl_b32 s66, s16, 12
    buffer_load_dwordx4 a[192:195], v3, s[44:47], s66 offen sc0 sc1
    s_lshl_b32 s66, s16, 12
    buffer_load_dwordx4 a[196:199], v3, s[44:47], s66 offen offset:1024 sc0 sc1
    v_mfma_f32_32x32x16_bf16 v[64:79], v[100:103], a[96:99], v[64:79]
    s_lshl_b32 s66, s16, 12
    buffer_load_dwordx4 a[200:203], v3, s[44:47], s66 offen offset:2048 sc0 sc1
    s_lshl_b32 s66, s16, 12
    buffer_load_dwordx4 a[204:207], v3, s[44:47], s66 offen offset:3072 sc0 sc1
    s_lshl_b32 s66, s17, 12
    buffer_load_dwordx4 a[208:211], v3, s[44:47], s66 offen sc0 sc1
    v_mfma_f32_32x32x16_bf16 v[80:95], v[100:103], a[104:107], v[80:95]
    s_lshl_b32 s66, s17, 12
    buffer_load_dwordx4 a[212:215], v3, s[44:47], s66 offen offset:1024 sc0 sc1
    s_lshl_b32 s66, s17, 12
    buffer_load_dwordx4 a[216:219], v3, s[44:47], s66 offen offset:2048 sc0 sc1
    s_lshl_b32 s66, s17, 12
    buffer_load_dwordx4 a[220:223], v3, s[44:47], s66 offen offset:3072 sc0 sc1
    v_mfma_f32_32x32x16_bf16 v[32:47], v[104:107], a[100:103], v[32:47]
    v_mfma_f32_32x32x16_bf16 v[48:63], v[104:107], a[108:111], v[48:63]
    v_mfma_f32_32x32x16_bf16 v[64:79], v[108:111], a[100:103], v[64:79]
    v_mfma_f32_32x32x16_bf16 v[80:95], v[108:111], a[108:111], v[80:95]
    s_waitcnt vmcnt(52) lgkmcnt(0)
    ds_read_b64_tr_b16 v[96:97], v14 offset:32768
    ds_read_b64_tr_b16 v[98:99], v14 offset:33792
    ds_read_b64_tr_b16 v[100:101], v15 offset:32768
    ds_read_b64_tr_b16 v[102:103], v15 offset:33792
    s_waitcnt vmcnt(32)
    v_mfma_f32_32x32x16_bf16 v[32:47], v[112:115], a[112:115], v[32:47]
    ds_read_b64_tr_b16 v[104:105], v14 offset:34816
    ds_read_b64_tr_b16 v[106:107], v14 offset:35840
    ds_read_b64_tr_b16 v[108:109], v15 offset:34816
    v_mfma_f32_32x32x16_bf16 v[48:63], v[112:115], a[120:123], v[48:63]
    ds_read_b64_tr_b16 v[110:111], v15 offset:35840
    v_lshrrev_b32 v29, 3, v1
    v_lshlrev_b32 v30, 2, v6
    s_lshl_b32 s65, s56, 6
    s_lshl_b32 s66, s58, 4
    s_add_u32 s65, s65, s66
    v_add_u32 v29, s65, v29
    v_lshl_add_u32 v4, v29, 10, v30
    s_lshl_b32 s68, s57, 7
    s_add_u32 s67, s68, 8192
    buffer_load_dwordx4 v[240:243], v4, s[24:27], s68 offen
    buffer_load_dwordx4 v[244:247], v4, s[24:27], s67 offen
    buffer_load_dwordx4 v[248:251], v30, s[36:39], s68 offen
    s_lshl_b32 s66, s60, 3
    s_add_u32 m0, s66, 0x10000
    s_lshl_b32 s65, s58, 17
    s_add_u32 s65, s65, 0
    buffer_load_dwordx4 v2, s[52:55], s65 offen lds
    v_mfma_f32_32x32x16_bf16 v[64:79], v[116:119], a[112:115], v[64:79]
    s_lshl_b32 s66, s60, 3
    s_add_u32 m0, s66, 0x10400
    s_lshl_b32 s65, s58, 17
    s_add_u32 s65, s65, 8192
    buffer_load_dwordx4 v2, s[52:55], s65 offen lds
    s_lshl_b32 s66, s60, 3
    s_add_u32 m0, s66, 0x10800
    s_lshl_b32 s65, s58, 17
    s_add_u32 s65, s65, 16384
    buffer_load_dwordx4 v2, s[52:55], s65 offen lds
    s_lshl_b32 s66, s60, 3
    s_add_u32 m0, s66, 0x10c00
    s_lshl_b32 s65, s58, 17
    s_add_u32 s65, s65, 24576
    buffer_load_dwordx4 v2, s[52:55], s65 offen lds
    v_mfma_f32_32x32x16_bf16 v[80:95], v[116:119], a[120:123], v[80:95]
    s_lshl_b32 s66, s60, 3
    s_add_u32 m0, s66, 0x11000
    s_lshl_b32 s65, s58, 17
    s_add_u32 s65, s65, 32768
    buffer_load_dwordx4 v2, s[52:55], s65 offen lds
    s_lshl_b32 s66, s60, 3
    s_add_u32 m0, s66, 0x11400
    s_lshl_b32 s65, s58, 17
    s_add_u32 s65, s65, 40960
    buffer_load_dwordx4 v2, s[52:55], s65 offen lds
    s_lshl_b32 s66, s60, 3
    s_add_u32 m0, s66, 0x11800
    s_lshl_b32 s65, s58, 17
    s_add_u32 s65, s65, 49152
    buffer_load_dwordx4 v2, s[52:55], s65 offen lds
    v_mfma_f32_32x32x16_bf16 v[32:47], v[120:123], a[116:119], v[32:47]
    s_lshl_b32 s66, s60, 3
    s_add_u32 m0, s66, 0x11c00
    s_lshl_b32 s65, s58, 17
    s_add_u32 s65, s65, 57344
    buffer_load_dwordx4 v2, s[52:55], s65 offen lds
    v_mfma_f32_32x32x16_bf16 v[48:63], v[120:123], a[124:127], v[48:63]
    v_mfma_f32_32x32x16_bf16 v[64:79], v[124:127], a[116:119], v[64:79]
    v_mfma_f32_32x32x16_bf16 v[80:95], v[124:127], a[124:127], v[80:95]
    s_waitcnt vmcnt(63) lgkmcnt(0)
    ds_read_b64_tr_b16 v[112:113], v14 offset:36864
    ds_read_b64_tr_b16 v[114:115], v14 offset:37888
    ds_read_b64_tr_b16 v[116:117], v15 offset:36864
    ds_read_b64_tr_b16 v[118:119], v15 offset:37888
    s_waitcnt vmcnt(39)
    v_mfma_f32_32x32x16_bf16 v[32:47], v[96:99], a[128:131], v[32:47]
    ds_read_b64_tr_b16 v[120:121], v14 offset:38912
    ds_read_b64_tr_b16 v[122:123], v14 offset:39936
    ds_read_b64_tr_b16 v[124:125], v15 offset:38912
    v_mfma_f32_32x32x16_bf16 v[48:63], v[96:99], a[136:139], v[48:63]
    ds_read_b64_tr_b16 v[126:127], v15 offset:39936
    s_lshl_b32 s65, s56, 7
    s_lshl_b32 s66, s58, 5
    s_add_u32 s65, s65, s66
    s_add_u32 s65, s65, 0x1a0c000
    buffer_load_dword v25, v6, s[44:47], s65 offen sc0 sc1
    v_mfma_f32_32x32x16_bf16 v[64:79], v[100:103], a[128:131], v[64:79]
    v_mfma_f32_32x32x16_bf16 v[80:95], v[100:103], a[136:139], v[80:95]
    v_mfma_f32_32x32x16_bf16 v[32:47], v[104:107], a[132:135], v[32:47]
    v_mfma_f32_32x32x16_bf16 v[48:63], v[104:107], a[140:143], v[48:63]
    v_mfma_f32_32x32x16_bf16 v[64:79], v[108:111], a[132:135], v[64:79]
    v_mfma_f32_32x32x16_bf16 v[80:95], v[108:111], a[140:143], v[80:95]
    s_waitcnt vmcnt(53) lgkmcnt(0)
    ds_read_b64_tr_b16 v[96:97], v12
    ds_read_b64_tr_b16 v[98:99], v12 offset:1024
    ds_read_b64_tr_b16 v[100:101], v13
    ds_read_b64_tr_b16 v[102:103], v13 offset:1024
    s_waitcnt vmcnt(36)
    v_mfma_f32_32x32x16_bf16 v[32:47], v[112:115], a[144:147], v[32:47]
    ds_read_b64_tr_b16 v[104:105], v12 offset:2048
    ds_read_b64_tr_b16 v[106:107], v12 offset:3072
    ds_read_b64_tr_b16 v[108:109], v13 offset:2048
    v_mfma_f32_32x32x16_bf16 v[48:63], v[112:115], a[152:155], v[48:63]
    ds_read_b64_tr_b16 v[110:111], v13 offset:3072
    s_lshl_b32 s66, s60, 3
    s_add_u32 m0, s66, 0x18000
    s_lshl_b32 s65, s58, 17
    s_add_u32 s65, s65, 65536
    buffer_load_dwordx4 v2, s[52:55], s65 offen lds
    s_lshl_b32 s66, s60, 3
    s_add_u32 m0, s66, 0x18400
    s_lshl_b32 s65, s58, 17
    s_add_u32 s65, s65, 73728
    buffer_load_dwordx4 v2, s[52:55], s65 offen lds
    v_mfma_f32_32x32x16_bf16 v[64:79], v[116:119], a[144:147], v[64:79]
    s_lshl_b32 s66, s60, 3
    s_add_u32 m0, s66, 0x18800
    s_lshl_b32 s65, s58, 17
    s_add_u32 s65, s65, 81920
    buffer_load_dwordx4 v2, s[52:55], s65 offen lds
    s_lshl_b32 s66, s60, 3
    s_add_u32 m0, s66, 0x18c00
    s_lshl_b32 s65, s58, 17
    s_add_u32 s65, s65, 90112
    buffer_load_dwordx4 v2, s[52:55], s65 offen lds
    s_lshl_b32 s66, s60, 3
    s_add_u32 m0, s66, 0x19000
    s_lshl_b32 s65, s58, 17
    s_add_u32 s65, s65, 98304
    buffer_load_dwordx4 v2, s[52:55], s65 offen lds
    v_mfma_f32_32x32x16_bf16 v[80:95], v[116:119], a[152:155], v[80:95]
    s_lshl_b32 s66, s60, 3
    s_add_u32 m0, s66, 0x19400
    s_lshl_b32 s65, s58, 17
    s_add_u32 s65, s65, 106496
    buffer_load_dwordx4 v2, s[52:55], s65 offen lds
    s_lshl_b32 s66, s60, 3
    s_add_u32 m0, s66, 0x19800
    s_lshl_b32 s65, s58, 17
    s_add_u32 s65, s65, 114688
    buffer_load_dwordx4 v2, s[52:55], s65 offen lds
    s_lshl_b32 s66, s60, 3
    s_add_u32 m0, s66, 0x19c00
    s_lshl_b32 s65, s58, 17
    s_add_u32 s65, s65, 122880
    buffer_load_dwordx4 v2, s[52:55], s65 offen lds
    v_mfma_f32_32x32x16_bf16 v[32:47], v[120:123], a[148:151], v[32:47]
    v_mfma_f32_32x32x16_bf16 v[48:63], v[120:123], a[156:159], v[48:63]
    v_mfma_f32_32x32x16_bf16 v[64:79], v[124:127], a[148:151], v[64:79]
    v_mfma_f32_32x32x16_bf16 v[80:95], v[124:127], a[156:159], v[80:95]
    s_waitcnt vmcnt(61) lgkmcnt(0)
    s_waitcnt vmcnt(8)
    s_mov_b32 s86, 0
L_of_chk:
    v_xor_b32 v29, s64, v25
    v_cmp_ne_u32 vcc, 0, v29
    s_nop 0
    s_cmp_eq_u64 vcc, 0
    s_cbranch_scc1 L_of_ok
    s_add_u32 s86, s86, 1
    s_cmp_ge_u32 s86, 200000
    s_cbranch_scc1 L_of_ok
    s_sleep 2
    s_lshl_b32 s65, s56, 7
    s_lshl_b32 s66, s58, 5
    s_add_u32 s65, s65, s66
    s_add_u32 s65, s65, 0x1a0c000
    buffer_load_dword v25, v6, s[44:47], s65 offen sc0 sc1
    s_waitcnt vmcnt(0)
    s_branch L_of_chk
L_of_ok:
    ds_read_b64_tr_b16 v[112:113], v12 offset:4096
    ds_read_b64_tr_b16 v[114:115], v12 offset:5120
    ds_read_b64_tr_b16 v[116:117], v13 offset:4096
    ds_read_b64_tr_b16 v[118:119], v13 offset:5120
    s_waitcnt vmcnt(40)
    v_mfma_f32_32x32x16_bf16 v[32:47], v[96:99], a[160:163], v[32:47]
    ds_read_b64_tr_b16 v[120:121], v12 offset:6144
    ds_read_b64_tr_b16 v[122:123], v12 offset:7168
    ds_read_b64_tr_b16 v[124:125], v13 offset:6144
    v_mfma_f32_32x32x16_bf16 v[48:63], v[96:99], a[168:171], v[48:63]
    ds_read_b64_tr_b16 v[126:127], v13 offset:7168
    s_lshl_b32 s66, s58, 14
    s_add_u32 s66, s66, 229376
    buffer_load_dwordx4 a[224:227], v3, s[44:47], s66 offen sc0 sc1
    s_lshl_b32 s66, s58, 14
    s_add_u32 s66, s66, 229376
    buffer_load_dwordx4 a[228:231], v3, s[44:47], s66 offen offset:1024 sc0 sc1
    v_mfma_f32_32x32x16_bf16 v[64:79], v[100:103], a[160:163], v[64:79]
    s_lshl_b32 s66, s58, 14
    s_add_u32 s66, s66, 229376
    buffer_load_dwordx4 a[232:235], v3, s[44:47], s66 offen offset:2048 sc0 sc1
    s_lshl_b32 s66, s58, 14
    s_add_u32 s66, s66, 229376
    buffer_load_dwordx4 a[236:239], v3, s[44:47], s66 offen offset:3072 sc0 sc1
    s_lshl_b32 s66, s58, 14
    s_add_u32 s66, s66, 233472
    buffer_load_dwordx4 a[240:243], v3, s[44:47], s66 offen sc0 sc1
    v_mfma_f32_32x32x16_bf16 v[80:95], v[100:103], a[168:171], v[80:95]
    s_lshl_b32 s66, s58, 14
    s_add_u32 s66, s66, 233472
    buffer_load_dwordx4 a[244:247], v3, s[44:47], s66 offen offset:1024 sc0 sc1
    s_lshl_b32 s66, s58, 14
    s_add_u32 s66, s66, 233472
    buffer_load_dwordx4 a[248:251], v3, s[44:47], s66 offen offset:2048 sc0 sc1
    s_lshl_b32 s66, s58, 14
    s_add_u32 s66, s66, 233472
    buffer_load_dwordx4 a[252:255], v3, s[44:47], s66 offen offset:3072 sc0 sc1
    v_mfma_f32_32x32x16_bf16 v[32:47], v[104:107], a[164:167], v[32:47]
    v_mfma_f32_32x32x16_bf16 v[48:63], v[104:107], a[172:175], v[48:63]
    v_mfma_f32_32x32x16_bf16 v[64:79], v[108:111], a[164:167], v[64:79]
    v_mfma_f32_32x32x16_bf16 v[80:95], v[108:111], a[172:175], v[80:95]
    s_waitcnt vmcnt(36) lgkmcnt(0)
    ds_read_b64_tr_b16 v[96:97], v12 offset:32768
    ds_read_b64_tr_b16 v[98:99], v12 offset:33792
    ds_read_b64_tr_b16 v[100:101], v13 offset:32768
    ds_read_b64_tr_b16 v[102:103], v13 offset:33792
    s_waitcnt vmcnt(44)
    v_mfma_f32_32x32x16_bf16 v[32:47], v[112:115], a[176:179], v[32:47]
    ds_read_b64_tr_b16 v[104:105], v12 offset:34816
    ds_read_b64_tr_b16 v[106:107], v12 offset:35840
    ds_read_b64_tr_b16 v[108:109], v13 offset:34816
    v_mfma_f32_32x32x16_bf16 v[48:63], v[112:115], a[184:187], v[48:63]
    ds_read_b64_tr_b16 v[110:111], v13 offset:35840
    s_lshl_b32 s66, s58, 14
    s_add_u32 s66, s66, 237568
    buffer_load_dwordx4 a[0:3], v3, s[44:47], s66 offen sc0 sc1
    s_lshl_b32 s66, s58, 14
    s_add_u32 s66, s66, 237568
    buffer_load_dwordx4 a[4:7], v3, s[44:47], s66 offen offset:1024 sc0 sc1
    v_mfma_f32_32x32x16_bf16 v[64:79], v[116:119], a[176:179], v[64:79]
    s_lshl_b32 s66, s58, 14
    s_add_u32 s66, s66, 237568
    buffer_load_dwordx4 a[8:11], v3, s[44:47], s66 offen offset:2048 sc0 sc1
    s_lshl_b32 s66, s58, 14
    s_add_u32 s66, s66, 237568
    buffer_load_dwordx4 a[12:15], v3, s[44:47], s66 offen offset:3072 sc0 sc1
    s_lshl_b32 s66, s58, 14
    s_add_u32 s66, s66, 241664
    buffer_load_dwordx4 a[16:19], v3, s[44:47], s66 offen sc0 sc1
    v_mfma_f32_32x32x16_bf16 v[80:95], v[116:119], a[184:187], v[80:95]
    s_lshl_b32 s66, s58, 14
    s_add_u32 s66, s66, 241664
    buffer_load_dwordx4 a[20:23], v3, s[44:47], s66 offen offset:1024 sc0 sc1
    s_lshl_b32 s66, s58, 14
    s_add_u32 s66, s66, 241664
    buffer_load_dwordx4 a[24:27], v3, s[44:47], s66 offen offset:2048 sc0 sc1
    s_lshl_b32 s66, s58, 14
    s_add_u32 s66, s66, 241664
    buffer_load_dwordx4 a[28:31], v3, s[44:47], s66 offen offset:3072 sc0 sc1
    v_mfma_f32_32x32x16_bf16 v[32:47], v[120:123], a[180:183], v[32:47]
    v_mfma_f32_32x32x16_bf16 v[48:63], v[120:123], a[188:191], v[48:63]
    v_mfma_f32_32x32x16_bf16 v[64:79], v[124:127], a[180:183], v[64:79]
    v_mfma_f32_32x32x16_bf16 v[80:95], v[124:127], a[188:191], v[80:95]
    s_waitcnt vmcnt(44) lgkmcnt(0)
    ds_read_b64_tr_b16 v[112:113], v12 offset:36864
    ds_read_b64_tr_b16 v[114:115], v12 offset:37888
    ds_read_b64_tr_b16 v[116:117], v13 offset:36864
    ds_read_b64_tr_b16 v[118:119], v13 offset:37888
    s_waitcnt vmcnt(40)
    v_mfma_f32_32x32x16_bf16 v[32:47], v[96:99], a[192:195], v[32:47]
    ds_read_b64_tr_b16 v[120:121], v12 offset:38912
    ds_read_b64_tr_b16 v[122:123], v12 offset:39936
    ds_read_b64_tr_b16 v[124:125], v13 offset:38912
    v_mfma_f32_32x32x16_bf16 v[48:63], v[96:99], a[200:203], v[48:63]
    ds_read_b64_tr_b16 v[126:127], v13 offset:39936
    v_mfma_f32_32x32x16_bf16 v[64:79], v[100:103], a[192:195], v[64:79]
    v_mfma_f32_32x32x16_bf16 v[80:95], v[100:103], a[200:203], v[80:95]
    v_mfma_f32_32x32x16_bf16 v[32:47], v[104:107], a[196:199], v[32:47]
    v_mfma_f32_32x32x16_bf16 v[48:63], v[104:107], a[204:207], v[48:63]
    v_mfma_f32_32x32x16_bf16 v[64:79], v[108:111], a[196:199], v[64:79]
    v_mfma_f32_32x32x16_bf16 v[80:95], v[108:111], a[204:207], v[80:95]
    s_waitcnt vmcnt(25) lgkmcnt(0)
    ds_read_b64_tr_b16 v[96:97], v14
    ds_read_b64_tr_b16 v[98:99], v14 offset:1024
    ds_read_b64_tr_b16 v[100:101], v15
    ds_read_b64_tr_b16 v[102:103], v15 offset:1024
    s_waitcnt vmcnt(36)
    v_mfma_f32_32x32x16_bf16 v[32:47], v[112:115], a[208:211], v[32:47]
    ds_read_b64_tr_b16 v[104:105], v14 offset:2048
    ds_read_b64_tr_b16 v[106:107], v14 offset:3072
    ds_read_b64_tr_b16 v[108:109], v15 offset:2048
    v_mfma_f32_32x32x16_bf16 v[48:63], v[112:115], a[216:219], v[48:63]
    ds_read_b64_tr_b16 v[110:111], v15 offset:3072
    v_mfma_f32_32x32x16_bf16 v[64:79], v[116:119], a[208:211], v[64:79]
    v_mfma_f32_32x32x16_bf16 v[80:95], v[116:119], a[216:219], v[80:95]
    v_mfma_f32_32x32x16_bf16 v[32:47], v[120:123], a[212:215], v[32:47]
    v_mfma_f32_32x32x16_bf16 v[48:63], v[120:123], a[220:223], v[48:63]
    v_mfma_f32_32x32x16_bf16 v[64:79], v[124:127], a[212:215], v[64:79]
    v_mfma_f32_32x32x16_bf16 v[80:95], v[124:127], a[220:223], v[80:95]
    s_waitcnt vmcnt(25) lgkmcnt(0)
    ds_read_b64_tr_b16 v[112:113], v14 offset:4096
    ds_read_b64_tr_b16 v[114:115], v14 offset:5120
    ds_read_b64_tr_b16 v[116:117], v15 offset:4096
    ds_read_b64_tr_b16 v[118:119], v15 offset:5120
    s_waitcnt vmcnt(12)
    v_mfma_f32_32x32x16_bf16 v[32:47], v[96:99], a[224:227], v[32:47]
    ds_read_b64_tr_b16 v[120:121], v14 offset:6144
    ds_read_b64_tr_b16 v[122:123], v14 offset:7168
    ds_read_b64_tr_b16 v[124:125], v15 offset:6144
    v_mfma_f32_32x32x16_bf16 v[48:63], v[96:99], a[232:235], v[48:63]
    ds_read_b64_tr_b16 v[126:127], v15 offset:7168
    v_mfma_f32_32x32x16_bf16 v[64:79], v[100:103], a[224:227], v[64:79]
    v_mfma_f32_32x32x16_bf16 v[80:95], v[100:103], a[232:235], v[80:95]
    v_mfma_f32_32x32x16_bf16 v[32:47], v[104:107], a[228:231], v[32:47]
    v_mfma_f32_32x32x16_bf16 v[48:63], v[104:107], a[236:239], v[48:63]
    v_mfma_f32_32x32x16_bf16 v[64:79], v[108:111], a[228:231], v[64:79]
    v_mfma_f32_32x32x16_bf16 v[80:95], v[108:111], a[236:239], v[80:95]
    s_waitcnt vmcnt(16) lgkmcnt(0)
    ds_read_b64_tr_b16 v[96:97], v14 offset:32768
    ds_read_b64_tr_b16 v[98:99], v14 offset:33792
    ds_read_b64_tr_b16 v[100:101], v15 offset:32768
    ds_read_b64_tr_b16 v[102:103], v15 offset:33792
    s_waitcnt vmcnt(8)
    v_mfma_f32_32x32x16_bf16 v[32:47], v[112:115], a[240:243], v[32:47]
    ds_read_b64_tr_b16 v[104:105], v14 offset:34816
    ds_read_b64_tr_b16 v[106:107], v14 offset:35840
    ds_read_b64_tr_b16 v[108:109], v15 offset:34816
    v_mfma_f32_32x32x16_bf16 v[48:63], v[112:115], a[248:251], v[48:63]
    ds_read_b64_tr_b16 v[110:111], v15 offset:35840
    v_mfma_f32_32x32x16_bf16 v[64:79], v[116:119], a[240:243], v[64:79]
    v_mfma_f32_32x32x16_bf16 v[80:95], v[116:119], a[248:251], v[80:95]
    v_mfma_f32_32x32x16_bf16 v[32:47], v[120:123], a[244:247], v[32:47]
    v_mfma_f32_32x32x16_bf16 v[48:63], v[120:123], a[252:255], v[48:63]
    v_mfma_f32_32x32x16_bf16 v[64:79], v[124:127], a[244:247], v[64:79]
    v_mfma_f32_32x32x16_bf16 v[80:95], v[124:127], a[252:255], v[80:95]
    s_waitcnt vmcnt(16) lgkmcnt(0)
    ds_read_b64_tr_b16 v[112:113], v14 offset:36864
    ds_read_b64_tr_b16 v[114:115], v14 offset:37888
    ds_read_b64_tr_b16 v[116:117], v15 offset:36864
    ds_read_b64_tr_b16 v[118:119], v15 offset:37888
    s_waitcnt vmcnt(4)
    v_mfma_f32_32x32x16_bf16 v[32:47], v[96:99], a[0:3], v[32:47]
    ds_read_b64_tr_b16 v[120:121], v14 offset:38912
    ds_read_b64_tr_b16 v[122:123], v14 offset:39936
    ds_read_b64_tr_b16 v[124:125], v15 offset:38912
    v_mfma_f32_32x32x16_bf16 v[48:63], v[96:99], a[8:11], v[48:63]
    ds_read_b64_tr_b16 v[126:127], v15 offset:39936
    v_mfma_f32_32x32x16_bf16 v[64:79], v[100:103], a[0:3], v[64:79]
    v_mfma_f32_32x32x16_bf16 v[80:95], v[100:103], a[8:11], v[80:95]
    v_mfma_f32_32x32x16_bf16 v[32:47], v[104:107], a[4:7], v[32:47]
    v_mfma_f32_32x32x16_bf16 v[48:63], v[104:107], a[12:15], v[48:63]
    v_mfma_f32_32x32x16_bf16 v[64:79], v[108:111], a[4:7], v[64:79]
    v_mfma_f32_32x32x16_bf16 v[80:95], v[108:111], a[12:15], v[80:95]
    s_waitcnt lgkmcnt(0)
    s_waitcnt vmcnt(0)
    v_mfma_f32_32x32x16_bf16 v[32:47], v[112:115], a[16:19], v[32:47]
    v_mfma_f32_32x32x16_bf16 v[48:63], v[112:115], a[24:27], v[48:63]
    v_mfma_f32_32x32x16_bf16 v[64:79], v[116:119], a[16:19], v[64:79]
    v_mfma_f32_32x32x16_bf16 v[80:95], v[116:119], a[24:27], v[80:95]
    v_mfma_f32_32x32x16_bf16 v[32:47], v[120:123], a[20:23], v[32:47]
    v_mfma_f32_32x32x16_bf16 v[48:63], v[120:123], a[28:31], v[48:63]
    v_mfma_f32_32x32x16_bf16 v[64:79], v[124:127], a[20:23], v[64:79]
    v_mfma_f32_32x32x16_bf16 v[80:95], v[124:127], a[28:31], v[80:95]
    v_lshrrev_b32 v29, 5, v1
    v_and_b32 v30, 15, v1
    v_xor_b32 v29, v29, v30
    v_lshlrev_b32 v29, 4, v29
    v_lshl_add_u32 v29, v30, 8, v29
    v_and_b32 v30, 16, v1
    v_lshl_add_u32 v29, v30, 11, v29
    s_lshl_b32 s66, s60, 3
    v_add_u32 v96, s66, v29
    v_xor_b32 v97, 32, v96
    v_xor_b32 v98, 64, v96
    v_xor_b32 v99, 96, v96
    v_xor_b32 v100, 128, v96
    v_xor_b32 v101, 160, v96
    v_xor_b32 v102, 192, v96
    v_xor_b32 v103, 224, v96
    v_add_u32 v104, 0x10000, v96
    v_add_u32 v105, 0x10000, v97
    v_add_u32 v106, 0x10000, v98
    v_add_u32 v107, 0x10000, v99
    v_add_u32 v108, 0x10000, v100
    v_add_u32 v109, 0x10000, v101
    v_add_u32 v110, 0x10000, v102
    v_add_u32 v111, 0x10000, v103
    ds_write_b128 v96, v[32:35]
    ds_write_b128 v97, v[36:39]
    ds_write_b128 v98, v[40:43]
    ds_write_b128 v99, v[44:47]
    ds_write_b128 v100, v[64:67]
    ds_write_b128 v101, v[68:71]
    ds_write_b128 v102, v[72:75]
    ds_write_b128 v103, v[76:79]
    ds_write_b128 v104, v[48:51]
    ds_write_b128 v105, v[52:55]
    ds_write_b128 v106, v[56:59]
    ds_write_b128 v107, v[60:63]
    ds_write_b128 v108, v[80:83]
    ds_write_b128 v109, v[84:87]
    ds_write_b128 v110, v[88:91]
    ds_write_b128 v111, v[92:95]
    v_lshrrev_b32 v29, 3, v1
    v_lshrrev_b32 v30, 1, v6
    v_xor_b32 v30, v30, v29
    v_lshlrev_b32 v30, 4, v30
    v_lshl_add_u32 v112, v29, 8, v30
    s_lshl_b32 s66, s58, 15
    v_add_u32 v112, s66, v112
    v_xor_b32 v113, 16, v112
    v_xor_b32 v114, 128, v112
    v_xor_b32 v115, 144, v112
    v_lshlrev_b32 v208, 16, v240
    v_and_b32 v209, 0xffff0000, v240
    v_lshlrev_b32 v210, 16, v241
    v_and_b32 v211, 0xffff0000, v241
    v_lshlrev_b32 v212, 16, v242
    v_and_b32 v213, 0xffff0000, v242
    v_lshlrev_b32 v214, 16, v243
    v_and_b32 v215, 0xffff0000, v243
    v_lshlrev_b32 v216, 16, v244
    v_and_b32 v217, 0xffff0000, v244
    v_lshlrev_b32 v218, 16, v245
    v_and_b32 v219, 0xffff0000, v245
    v_lshlrev_b32 v220, 16, v246
    v_and_b32 v221, 0xffff0000, v246
    v_lshlrev_b32 v222, 16, v247
    v_and_b32 v223, 0xffff0000, v247
    v_lshlrev_b32 v224, 16, v248
    v_and_b32 v225, 0xffff0000, v248
    v_lshlrev_b32 v226, 16, v249
    v_and_b32 v227, 0xffff0000, v249
    v_lshlrev_b32 v228, 16, v250
    v_and_b32 v229, 0xffff0000, v250
    v_lshlrev_b32 v230, 16, v251
    v_and_b32 v231, 0xffff0000, v251
    v_pk_add_f32 v[208:209], v[208:209], v[224:225]
    v_pk_add_f32 v[210:211], v[210:211], v[226:227]
    v_pk_add_f32 v[212:213], v[212:213], v[228:229]
    v_pk_add_f32 v[214:215], v[214:215], v[230:231]
    v_pk_add_f32 v[216:217], v[216:217], v[224:225]
    v_pk_add_f32 v[218:219], v[218:219], v[226:227]
    v_pk_add_f32 v[220:221], v[220:221], v[228:229]
    v_pk_add_f32 v[222:223], v[222:223], v[230:231]
    s_waitcnt lgkmcnt(0)
    s_barrier
    ds_read_b128 v[128:131], v112
    ds_read_b128 v[132:135], v113
    ds_read_b128 v[136:139], v112 offset:8192
    ds_read_b128 v[140:143], v113 offset:8192
    ds_read_b128 v[144:147], v112 offset:16384
    ds_read_b128 v[148:151], v113 offset:16384
    ds_read_b128 v[152:155], v112 offset:24576
    ds_read_b128 v[156:159], v113 offset:24576
    ds_read_b128 v[160:163], v114 offset:2048
    ds_read_b128 v[164:167], v115 offset:2048
    ds_read_b128 v[168:171], v114 offset:10240
    ds_read_b128 v[172:175], v115 offset:10240
    ds_read_b128 v[176:179], v114 offset:18432
    ds_read_b128 v[180:183], v115 offset:18432
    ds_read_b128 v[184:187], v114 offset:26624
    ds_read_b128 v[188:191], v115 offset:26624
    s_waitcnt lgkmcnt(14)
    v_pk_add_f32 v[208:209], v[208:209], v[128:129]
    v_pk_add_f32 v[210:211], v[210:211], v[130:131]
    v_pk_add_f32 v[212:213], v[212:213], v[132:133]
    v_pk_add_f32 v[214:215], v[214:215], v[134:135]
    s_waitcnt lgkmcnt(12)
    v_pk_add_f32 v[208:209], v[208:209], v[136:137]
    v_pk_add_f32 v[210:211], v[210:211], v[138:139]
    v_pk_add_f32 v[212:213], v[212:213], v[140:141]
    v_pk_add_f32 v[214:215], v[214:215], v[142:143]
    s_waitcnt lgkmcnt(10)
    v_pk_add_f32 v[208:209], v[208:209], v[144:145]
    v_pk_add_f32 v[210:211], v[210:211], v[146:147]
    v_pk_add_f32 v[212:213], v[212:213], v[148:149]
    v_pk_add_f32 v[214:215], v[214:215], v[150:151]
    s_waitcnt lgkmcnt(8)
    v_pk_add_f32 v[208:209], v[208:209], v[152:153]
    v_pk_add_f32 v[210:211], v[210:211], v[154:155]
    v_pk_add_f32 v[212:213], v[212:213], v[156:157]
    v_pk_add_f32 v[214:215], v[214:215], v[158:159]
    v_cvt_pk_bf16_f32 v232, v208, v209
    v_cvt_pk_bf16_f32 v233, v210, v211
    v_cvt_pk_bf16_f32 v234, v212, v213
    v_cvt_pk_bf16_f32 v235, v214, v215
    buffer_store_dwordx4 v[232:235], v4, s[40:43], s68 offen
    s_waitcnt lgkmcnt(6)
    v_pk_add_f32 v[216:217], v[216:217], v[160:161]
    v_pk_add_f32 v[218:219], v[218:219], v[162:163]
    v_pk_add_f32 v[220:221], v[220:221], v[164:165]
    v_pk_add_f32 v[222:223], v[222:223], v[166:167]
    s_waitcnt lgkmcnt(4)
    v_pk_add_f32 v[216:217], v[216:217], v[168:169]
    v_pk_add_f32 v[218:219], v[218:219], v[170:171]
    v_pk_add_f32 v[220:221], v[220:221], v[172:173]
    v_pk_add_f32 v[222:223], v[222:223], v[174:175]
    s_waitcnt lgkmcnt(2)
    v_pk_add_f32 v[216:217], v[216:217], v[176:177]
    v_pk_add_f32 v[218:219], v[218:219], v[178:179]
    v_pk_add_f32 v[220:221], v[220:221], v[180:181]
    v_pk_add_f32 v[222:223], v[222:223], v[182:183]
    s_waitcnt lgkmcnt(0)
    v_pk_add_f32 v[216:217], v[216:217], v[184:185]
    v_pk_add_f32 v[218:219], v[218:219], v[186:187]
    v_pk_add_f32 v[220:221], v[220:221], v[188:189]
    v_pk_add_f32 v[222:223], v[222:223], v[190:191]
    v_cvt_pk_bf16_f32 v236, v216, v217
    v_cvt_pk_bf16_f32 v237, v218, v219
    v_cvt_pk_bf16_f32 v238, v220, v221
    v_cvt_pk_bf16_f32 v239, v222, v223
    buffer_store_dwordx4 v[236:239], v4, s[40:43], s67 offen
    s_or_b32 s65, s2, s58
    s_cmp_lg_u32 s65, 0
    s_cbranch_scc1 L_noep
    s_mov_b32 s65, 0x1a00000
    v_mov_b32 v29, 0
    v_mov_b32 v30, s64
    s_mov_b64 exec, 1
    buffer_store_dword v30, v29, s[44:47], s65 offen sc0 sc1
    s_mov_b64 exec, -1
L_noep:
L_end:
    s_endpgm
L_code_end:
.section .rodata,"a"
.p2align 6
.amdhsa_kernel parallel_sum__linear_kernel_hedgehog__dense_activation_squared_relu__prompt_kernel
  .amdhsa_next_free_vgpr 512
  .amdhsa_next_free_sgpr 102
  .amdhsa_accum_offset 256
  .amdhsa_group_segment_fixed_size 0
  .amdhsa_kernarg_size 96
  .amdhsa_user_sgpr_count 2
  .amdhsa_user_sgpr_kernarg_segment_ptr 1
  .amdhsa_system_sgpr_workgroup_id_x 1
  .amdhsa_float_denorm_mode_32 3
  .amdhsa_float_denorm_mode_16_64 3
.end_amdhsa_kernel
```
